```python
import torch

def _softmax(x, axis=-1):
    return torch.softmax(x, dim=axis)
def _gelu(x):
    return torch.nn.functional.gelu(x, approximate="tanh")
def _silu(x):
    return torch.nn.functional.silu(x)
def _sigmoid(x):
    return torch.sigmoid(x)
def _layernorm(x, axis=-1, eps=1e-5):
    m = x.mean(dim=axis, keepdim=True)
    v = x.var(dim=axis, keepdim=True, unbiased=False)
    return (x - m) / torch.sqrt(v + eps)
def _scatter_add(tgt, idx, src, axis=0):
    return tgt.clone().index_add_(axis, idx, src)
def _segment_sum(src, seg, n):
    out = torch.zeros((n,) + src.shape[1:], dtype=src.dtype)
    return out.index_add_(0, seg, src)
def _pad(x, pw):
    flat = tuple(v for pair in reversed(pw) for v in pair)
    return torch.nn.functional.pad(x, flat)

kernel_name = 'gated_mix__sliding_local_dilated__dense_activation_relu__prompt'

def setup_inputs():

    _w = (lambda a: (lambda t: t.to(torch.bfloat16) if t.is_floating_point() else t)(torch.as_tensor(a)))
    def _A_setup():
        B, S, D = 1, 2048, 640
        return {
            "x": _w((lambda *s: torch.randn(*s, dtype=torch.bfloat16) * 0.05)(B, S, D)),
            "wqkv": _w((lambda *s: torch.randn(*s, dtype=torch.bfloat16) * 0.8)(D, 3 * D)),
            "wo": _w((lambda *s: torch.randn(*s, dtype=torch.bfloat16) * 0.05)(D, D)),
        }
    _A_in = _A_setup()

    def _B_setup():
        B, S, D, Dff = 1, 2048, 640, 1536
        return {
            "x": _w((lambda *s: torch.randn(*s, dtype=torch.bfloat16) * 0.05)(B, S, D)),
            "w1": _w((lambda *s: torch.randn(*s, dtype=torch.bfloat16) * 0.2)(D, Dff)),
            "w2": _w((lambda *s: torch.randn(*s, dtype=torch.bfloat16) * 0.2)(Dff, D)),
        }
    _B_in = _B_setup()

    return {
        "A_x": _A_in["x"],
        "A_wqkv": _A_in["wqkv"],
        "A_wo": _A_in["wo"],
        "B_x": _B_in["x"],
        "B_w1": _B_in["w1"],
        "B_w2": _B_in["w2"],
        "gate_w": _w((lambda *s: torch.randn(*s, dtype=torch.bfloat16) * 0.05)(640) * 16.0),
    }

def reference(A_x, A_wqkv, A_wo, B_x, B_w1, B_w2, gate_w):
    def _A_ref(x, wqkv, wo):
        B, S, D = x.shape
        H = 32; Dh = D // H
        W, dil = 8, 2
        qkv = (lambda x, *d: x.permute(*d))((x @ wqkv).reshape(B, S, 3, H, Dh), 2, 0, 3, 1, 4)
        q, k, v = qkv[0], qkv[1], qkv[2]
        scale = Dh ** -0.5
        pos = torch.arange(S)
        off = torch.arange(W) * dil
        idx = pos[:, None] - off[None, :]
        mask = idx >= 0
        idx_c = torch.where(mask, idx, 0).reshape(-1)
        kg = k[:, :, idx_c, :].reshape(B, H, S, W, Dh)
        vg = v[:, :, idx_c, :].reshape(B, H, S, W, Dh)
        logits = torch.einsum("bhsd,bhswd->bhsw", q, kg) * scale
        logits = torch.where(mask[None, None, :, :], logits, -1e9)
        attn = _softmax(logits, axis=-1)
        o = torch.einsum("bhsw,bhswd->bhsd", attn, vg)
        return (lambda x, *d: x.permute(*d))(o, 0, 2, 1, 3).reshape(B, S, D) @ wo

    def _B_ref(x, w1, w2):
        h = torch.einsum("bsd,df->bsf", x, w1)
        zero = torch.zeros_like(h)
        h = torch.maximum(h, zero)
        return torch.einsum("bsf,fd->bsd", h, w2)

    x = A_x
    g = _sigmoid((x * gate_w).sum(-1, keepdims=True))
    a = _A_ref(x, A_wqkv, A_wo)
    b = _B_ref(x, B_w1, B_w2)
    return g * a + (1 - g) * b
```

```asm
; @launch kernel=gated_mix__sliding_local_dilated__dense_activation_relu__prompt_kernel grid=(256,1,1) block=(512,1,1) lds=150528
; @launch kernel=gm_stage2_kernel grid=(256,1,1) block=(256,1,1) lds=102400
.amdgcn_target "amdgcn-amd-amdhsa--gfx950"
.text
.globl gated_mix__sliding_local_dilated__dense_activation_relu__prompt_kernel
.p2align 8
.type gated_mix__sliding_local_dilated__dense_activation_relu__prompt_kernel,@function
gated_mix__sliding_local_dilated__dense_activation_relu__prompt_kernel:
    s_cmp_ge_u32 s2, 256
    s_nop 0
    s_cbranch_scc1 L1_end
    s_load_dwordx4 s[4:7], s[0:1], 0
    s_load_dwordx2 s[8:9], s[0:1], 16
    s_load_dwordx4 s[12:15], s[0:1], 32
    s_load_dwordx2 s[10:11], s[0:1], 48
    s_load_dwordx2 s[16:17], s[0:1], 72
    v_lshrrev_b32 v1, 6, v0
    v_and_b32 v0, 63, v0
    v_readfirstlane_b32 s3, v1
    s_and_b32 s33, s2, 7
    s_lshr_b32 s34, s2, 3
    s_lshr_b32 s35, s33, 2
    s_and_b32 s36, s33, 3
    s_cmp_ge_u32 s34, 30
    s_cbranch_scc1 L1_prep
    s_cmp_ge_u32 s34, 18
    s_cbranch_scc1 L1_ffn_setup
    s_and_b32 s38, s34, 1
    s_lshl_b32 s46, s36, 1
    s_add_u32 s38, s38, s46
    s_mul_i32 s37, s35, 9
    s_lshr_b32 s46, s34, 1
    s_add_u32 s37, s37, s46
    s_and_b32 s45, s46, 15
    s_mul_i32 s45, s45, 0
    s_and_b32 s47, s38, 1
    s_mul_i32 s47, s47, 0
    s_add_u32 s45, s45, s47
    s_mul_i32 s39, s37, 114
    s_nop 0
    s_movk_i32 s40, 3840
    s_movk_i32 s41, 29
    s_movk_i32 s42, 1120
    s_mul_i32 s43, s38, 160
    s_mov_b32 s44, 0
    s_waitcnt lgkmcnt(0)
    s_mov_b32 s24, s6
    s_mov_b32 s25, s7
    s_mov_b32 s26, 2457600
    s_mov_b32 s27, 0x00020000
    s_branch L1_common
    s_nop 0
L1_ffn_setup:
    s_mul_i32 s46, s36, 12
    s_add_u32 s46, s46, s34
    s_sub_u32 s46, s46, 18
    s_lshr_b32 s38, s46, 3
    s_and_b32 s46, s46, 7
    s_lshl_b32 s37, s35, 3
    s_add_u32 s37, s37, s46
    s_and_b32 s45, s46, 15
    s_mul_i32 s45, s45, 0
    s_and_b32 s47, s38, 1
    s_mul_i32 s47, s47, 0
    s_add_u32 s45, s45, s47
    s_add_u32 s45, s45, 0
    s_lshl_b32 s39, s37, 7
    s_movk_i32 s40, 3072
    s_movk_i32 s41, 31
    s_mov_b32 s42, 0
    s_lshl_b32 s43, s38, 9
    s_mov_b32 s44, 1
    s_waitcnt lgkmcnt(0)
    s_mov_b32 s24, s12
    s_mov_b32 s25, s13
    s_mov_b32 s26, 1966080
    s_mov_b32 s27, 0x00020000
L1_common:
    s_mov_b32 s20, s4
    s_mov_b32 s21, s5
    s_mov_b32 s22, 2621440
    s_mov_b32 s23, 0x00020000
    s_cmp_lt_u32 s3, 4
    s_cbranch_scc1 L1_consumer
    s_setprio 3
    s_sub_u32 s46, s3, 4
    v_lshrrev_b32 v2, 3, v0
    v_lshrrev_b32 v3, 4, v0
    v_and_b32 v4, 7, v0
    s_lshr_b32 s47, s46, 1
    s_add_u32 s47, s47, s39
    s_and_b32 s48, s46, 1
    s_lshl_b32 s48, s48, 6
    s_add_u32 s47, s47, s48
    v_lshl_add_u32 v5, v2, 1, s47
    v_mul_u32_u24 v5, 0x500, v5
    v_xor_b32_e64 v4, v4, v3
    v_lshl_add_u32 v16, v4, 4, v5
    v_xor_b32_e64 v4, 4, v4
    v_lshl_add_u32 v17, v4, 4, v5
    v_add_u32 v17, 20480, v17
    v_add_u32 v18, 40960, v16
    v_add_u32 v19, 40960, v17
    v_and_b32 v1, 31, v0
    v_min_u32 v1, s41, v1
    v_mul_u32_u24 v2, 13, v1
    v_lshrrev_b32 v2, 7, v2
    v_lshlrev_b32_e64 v1, 4, v1
    v_mad_u32_u24 v1, v2, s42, v1
    v_add_u32 v1, s43, v1
    v_lshrrev_b32 v2, 5, v0
    v_lshlrev_b32 v2, 2, v2
    s_lshl_b32 s47, s46, 4
    v_add_u32_e64 v2, s47, v2
    v_mad_u32_u24 v8, v2, s40, v1
    s_lshl_b32 s47, s40, 3
    v_add_u32 v12, s47, v8
    v_add_u32 v9, s40, v8
    v_add_u32 v13, s40, v12
    v_add_u32 v10, s40, v9
    v_add_u32 v14, s40, v13
    v_add_u32 v11, s40, v10
    v_add_u32 v15, s40, v14
    s_mul_i32 s47, s45, 205
    s_lshr_b32 s47, s47, 11
    s_mul_i32 s47, s47, 10
    s_sub_u32 s45, s45, s47
    s_mov_b32 s48, 0
    s_mov_b32 s49, 0
    s_mul_i32 s50, s46, 8448
    s_lshl_b32 s51, s46, 12
    s_add_u32 s51, s51, 33792
    s_nop 0
    s_lshl_b32 s53, s40, 6
    s_movk_i32 s55, 1024
    s_movk_i32 s47, 1056
    s_mul_i32 s52, s45, s53
    s_lshl_b32 s54, s45, 7
    s_add_u32 m0, s49, s51
    s_nop 0
    buffer_load_dwordx4 v16, s[20:23], s54 offen lds
    s_add_u32 m0, m0, s55
    s_nop 0
    buffer_load_dwordx4 v17, s[20:23], s54 offen lds
    s_add_u32 m0, m0, s55
    s_nop 0
    buffer_load_dwordx4 v18, s[20:23], s54 offen lds
    s_add_u32 m0, m0, s55
    s_nop 0
    buffer_load_dwordx4 v19, s[20:23], s54 offen lds
    s_add_u32 m0, s49, s50
    s_nop 0
    buffer_load_dwordx4 v8, s[24:27], s52 offen lds
    s_add_u32 m0, m0, s47
    s_nop 0
    buffer_load_dwordx4 v9, s[24:27], s52 offen lds
    s_add_u32 m0, m0, s47
    s_nop 0
    buffer_load_dwordx4 v10, s[24:27], s52 offen lds
    s_add_u32 m0, m0, s47
    s_nop 0
    buffer_load_dwordx4 v11, s[24:27], s52 offen lds
    s_add_u32 m0, m0, s47
    s_nop 0
    buffer_load_dwordx4 v12, s[24:27], s52 offen lds
    s_add_u32 m0, m0, s47
    s_nop 0
    buffer_load_dwordx4 v13, s[24:27], s52 offen lds
    s_add_u32 m0, m0, s47
    s_nop 0
    buffer_load_dwordx4 v14, s[24:27], s52 offen lds
    s_add_u32 m0, m0, s47
    s_nop 0
    buffer_load_dwordx4 v15, s[24:27], s52 offen lds
    s_add_u32 s45, s45, 1
    s_cmp_eq_u32 s45, 10
    s_cselect_b32 s45, 0, s45
    s_add_u32 s49, s49, 50176
    s_cmp_eq_u32 s49, 150528
    s_cselect_b32 s49, 0, s49
    s_mov_b32 s56, s6
    s_mov_b32 s57, s7
    s_mov_b32 s58, 2457600
    s_mov_b32 s59, 0x00020000
    s_mov_b32 s60, s12
    s_mov_b32 s61, s13
    s_mov_b32 s62, 1966080
    s_mov_b32 s63, 0x00020000
    s_nop 0
    s_lshl_b32 s64, s33, 7
    s_lshl_b32 s65, s34, 2
    s_add_u32 s64, s64, s65
    s_add_u32 s64, s64, s46
    s_lshl_b32 s65, s64, 10
    v_lshl_add_u32 v32, v0, 4, s65
    v_add_u32 v33, 2342912, v32
    v_add_u32 v34, 1245184, v32
    s_mul_i32 s65, s64, 2560
    v_lshrrev_b32_e64 v35, 5, v0
    v_mul_u32_u24 v35, 0x500, v35
    v_and_b32_e64 v36, 31, v0
    v_lshl_add_u32 v35, v36, 4, v35
    v_lshrrev_b32_e64 v36, 3, v0
    v_mul_u32_u24 v36, 0x500, v36
    v_and_b32_e64 v37, 7, v0
    v_lshl_add_u32 v36, v37, 4, v36
    v_mov_b32 v37, 0x40000000
    v_cmp_gt_u32 vcc, 16, v0
    s_nop 1
    v_cndmask_b32 v36, v37, v36, vcc
    s_mov_b32 s66, 245760
    s_mov_b32 s67, 196608
    s_mov_b32 s68, 1294336
    buffer_load_dwordx4 v[40:43], v35, s[20:23], s65 offen offset:128
    buffer_load_dwordx4 v[44:47], v32, s[56:59], s66 offen offset:0
    buffer_load_dwordx4 v[48:51], v32, s[60:63], s67 offen offset:0
    s_mul_i32 s52, s45, s53
    s_lshl_b32 s54, s45, 7
    s_add_u32 m0, s49, s51
    s_nop 0
    buffer_load_dwordx4 v16, s[20:23], s54 offen lds
    s_add_u32 m0, m0, s55
    s_nop 0
    buffer_load_dwordx4 v17, s[20:23], s54 offen lds
    s_add_u32 m0, m0, s55
    s_nop 0
    buffer_load_dwordx4 v18, s[20:23], s54 offen lds
    s_add_u32 m0, m0, s55
    s_nop 0
    buffer_load_dwordx4 v19, s[20:23], s54 offen lds
    s_add_u32 m0, s49, s50
    s_nop 0
    buffer_load_dwordx4 v8, s[24:27], s52 offen lds
    s_add_u32 m0, m0, s47
    s_nop 0
    buffer_load_dwordx4 v9, s[24:27], s52 offen lds
    s_add_u32 m0, m0, s47
    s_nop 0
    buffer_load_dwordx4 v10, s[24:27], s52 offen lds
    s_add_u32 m0, m0, s47
    s_nop 0
    buffer_load_dwordx4 v11, s[24:27], s52 offen lds
    s_add_u32 m0, m0, s47
    s_nop 0
    buffer_load_dwordx4 v12, s[24:27], s52 offen lds
    s_add_u32 m0, m0, s47
    s_nop 0
    buffer_load_dwordx4 v13, s[24:27], s52 offen lds
    s_add_u32 m0, m0, s47
    s_nop 0
    buffer_load_dwordx4 v14, s[24:27], s52 offen lds
    s_add_u32 m0, m0, s47
    s_nop 0
    buffer_load_dwordx4 v15, s[24:27], s52 offen lds
    s_add_u32 s45, s45, 1
    s_cmp_eq_u32 s45, 10
    s_cselect_b32 s45, 0, s45
    s_add_u32 s49, s49, 50176
    s_cmp_eq_u32 s49, 150528
    s_cselect_b32 s49, 0, s49
    s_waitcnt vmcnt(15)
    s_barrier
    s_mul_i32 s52, s45, s53
    s_lshl_b32 s54, s45, 7
    s_add_u32 m0, s49, s51
    s_nop 0
    buffer_load_dwordx4 v16, s[20:23], s54 offen lds
    s_add_u32 m0, m0, s55
    s_nop 0
    buffer_load_dwordx4 v17, s[20:23], s54 offen lds
    s_add_u32 m0, m0, s55
    s_nop 0
    buffer_load_dwordx4 v18, s[20:23], s54 offen lds
    s_add_u32 m0, m0, s55
    s_nop 0
    buffer_load_dwordx4 v19, s[20:23], s54 offen lds
    s_add_u32 m0, s49, s50
    s_nop 0
    buffer_load_dwordx4 v8, s[24:27], s52 offen lds
    s_add_u32 m0, m0, s47
    s_nop 0
    buffer_load_dwordx4 v9, s[24:27], s52 offen lds
    s_add_u32 m0, m0, s47
    s_nop 0
    buffer_load_dwordx4 v10, s[24:27], s52 offen lds
    s_add_u32 m0, m0, s47
    s_nop 0
    buffer_load_dwordx4 v11, s[24:27], s52 offen lds
    s_add_u32 m0, m0, s47
    s_nop 0
    buffer_load_dwordx4 v12, s[24:27], s52 offen lds
    s_add_u32 m0, m0, s47
    s_nop 0
    buffer_load_dwordx4 v13, s[24:27], s52 offen lds
    s_add_u32 m0, m0, s47
    s_nop 0
    buffer_load_dwordx4 v14, s[24:27], s52 offen lds
    s_add_u32 m0, m0, s47
    s_nop 0
    buffer_load_dwordx4 v15, s[24:27], s52 offen lds
    s_add_u32 s45, s45, 1
    s_cmp_eq_u32 s45, 10
    s_cselect_b32 s45, 0, s45
    s_add_u32 s49, s49, 50176
    s_cmp_eq_u32 s49, 150528
    s_cselect_b32 s49, 0, s49
    buffer_load_dwordx4 v[52:55], v35, s[20:23], s65 offen offset:640
    buffer_load_dwordx4 v[56:59], v32, s[56:59], s68 offen offset:0
    buffer_load_dwordx4 v[60:63], v34, s[60:63], 0 offen offset:0
    buffer_load_dwordx4 v[64:67], v36, s[20:23], s65 offen offset:1152
    buffer_load_dwordx4 v[68:71], v33, s[56:59], 0 offen offset:0
    s_waitcnt vmcnt(17)
    s_barrier
    s_mul_i32 s52, s45, s53
    s_lshl_b32 s54, s45, 7
    s_add_u32 m0, s49, s51
    s_nop 0
    buffer_load_dwordx4 v16, s[20:23], s54 offen lds
    s_add_u32 m0, m0, s55
    s_nop 0
    buffer_load_dwordx4 v17, s[20:23], s54 offen lds
    s_add_u32 m0, m0, s55
    s_nop 0
    buffer_load_dwordx4 v18, s[20:23], s54 offen lds
    s_add_u32 m0, m0, s55
    s_nop 0
    buffer_load_dwordx4 v19, s[20:23], s54 offen lds
    s_add_u32 m0, s49, s50
    s_nop 0
    buffer_load_dwordx4 v8, s[24:27], s52 offen lds
    s_add_u32 m0, m0, s47
    s_nop 0
    buffer_load_dwordx4 v9, s[24:27], s52 offen lds
    s_add_u32 m0, m0, s47
    s_nop 0
    buffer_load_dwordx4 v10, s[24:27], s52 offen lds
    s_add_u32 m0, m0, s47
    s_nop 0
    buffer_load_dwordx4 v11, s[24:27], s52 offen lds
    s_add_u32 m0, m0, s47
    s_nop 0
    buffer_load_dwordx4 v12, s[24:27], s52 offen lds
    s_add_u32 m0, m0, s47
    s_nop 0
    buffer_load_dwordx4 v13, s[24:27], s52 offen lds
    s_add_u32 m0, m0, s47
    s_nop 0
    buffer_load_dwordx4 v14, s[24:27], s52 offen lds
    s_add_u32 m0, m0, s47
    s_nop 0
    buffer_load_dwordx4 v15, s[24:27], s52 offen lds
    s_add_u32 s45, s45, 1
    s_cmp_eq_u32 s45, 10
    s_cselect_b32 s45, 0, s45
    s_add_u32 s49, s49, 50176
    s_cmp_eq_u32 s49, 150528
    s_cselect_b32 s49, 0, s49
    s_waitcnt vmcnt(17)
    s_barrier
    s_mul_i32 s52, s45, s53
    s_lshl_b32 s54, s45, 7
    s_add_u32 m0, s49, s51
    s_nop 0
    buffer_load_dwordx4 v16, s[20:23], s54 offen lds
    s_add_u32 m0, m0, s55
    s_nop 0
    buffer_load_dwordx4 v17, s[20:23], s54 offen lds
    s_add_u32 m0, m0, s55
    s_nop 0
    buffer_load_dwordx4 v18, s[20:23], s54 offen lds
    s_add_u32 m0, m0, s55
    s_nop 0
    buffer_load_dwordx4 v19, s[20:23], s54 offen lds
    s_add_u32 m0, s49, s50
    s_nop 0
    buffer_load_dwordx4 v8, s[24:27], s52 offen lds
    s_add_u32 m0, m0, s47
    s_nop 0
    buffer_load_dwordx4 v9, s[24:27], s52 offen lds
    s_add_u32 m0, m0, s47
    s_nop 0
    buffer_load_dwordx4 v10, s[24:27], s52 offen lds
    s_add_u32 m0, m0, s47
    s_nop 0
    buffer_load_dwordx4 v11, s[24:27], s52 offen lds
    s_add_u32 m0, m0, s47
    s_nop 0
    buffer_load_dwordx4 v12, s[24:27], s52 offen lds
    s_add_u32 m0, m0, s47
    s_nop 0
    buffer_load_dwordx4 v13, s[24:27], s52 offen lds
    s_add_u32 m0, m0, s47
    s_nop 0
    buffer_load_dwordx4 v14, s[24:27], s52 offen lds
    s_add_u32 m0, m0, s47
    s_nop 0
    buffer_load_dwordx4 v15, s[24:27], s52 offen lds
    s_nop 0
    s_add_u32 s45, s45, 1
    s_cmp_eq_u32 s45, 10
    s_cselect_b32 s45, 0, s45
    s_add_u32 s49, s49, 50176
    s_cmp_eq_u32 s49, 150528
    s_cselect_b32 s49, 0, s49
    s_mov_b32 s48, 5
    s_waitcnt vmcnt(12)
L1_ld_loop:
    s_barrier
    s_mul_i32 s52, s45, s53
    s_lshl_b32 s54, s45, 7
    s_add_u32 m0, s49, s51
    s_nop 0
    buffer_load_dwordx4 v16, s[20:23], s54 offen lds
    s_add_u32 m0, m0, s55
    s_nop 0
    buffer_load_dwordx4 v17, s[20:23], s54 offen lds
    s_add_u32 m0, m0, s55
    s_nop 0
    buffer_load_dwordx4 v18, s[20:23], s54 offen lds
    s_add_u32 m0, m0, s55
    s_nop 0
    buffer_load_dwordx4 v19, s[20:23], s54 offen lds
    s_add_u32 m0, s49, s50
    s_nop 0
    buffer_load_dwordx4 v8, s[24:27], s52 offen lds
    s_add_u32 m0, m0, s47
    s_nop 0
    buffer_load_dwordx4 v9, s[24:27], s52 offen lds
    s_add_u32 m0, m0, s47
    s_nop 0
    buffer_load_dwordx4 v10, s[24:27], s52 offen lds
    s_add_u32 m0, m0, s47
    s_nop 0
    buffer_load_dwordx4 v11, s[24:27], s52 offen lds
    s_add_u32 m0, m0, s47
    s_nop 0
    buffer_load_dwordx4 v12, s[24:27], s52 offen lds
    s_add_u32 m0, m0, s47
    s_nop 0
    buffer_load_dwordx4 v13, s[24:27], s52 offen lds
    s_add_u32 m0, m0, s47
    s_nop 0
    buffer_load_dwordx4 v14, s[24:27], s52 offen lds
    s_add_u32 m0, m0, s47
    s_nop 0
    buffer_load_dwordx4 v15, s[24:27], s52 offen lds
    s_add_u32 s45, s45, 1
    s_cmp_eq_u32 s45, 10
    s_cselect_b32 s45, 0, s45
    s_add_u32 s49, s49, 50176
    s_cmp_eq_u32 s49, 150528
    s_cselect_b32 s49, 0, s49
    s_add_u32 s48, s48, 1
    s_cmp_lt_u32 s48, 10
    s_waitcnt vmcnt(12)
    s_cbranch_scc1 L1_ld_loop
    s_cmp_eq_u32 s44, 1
    s_cselect_b32 s47, s38, 4
    s_cmp_lt_u32 s47, 4
    s_barrier
    s_cbranch_scc1 L1_ld_gate
    s_waitcnt vmcnt(0)
    s_barrier
    s_endpgm
L1_ld_gate:
    s_mov_b32 s56, s10
    s_mov_b32 s57, s11
    s_mov_b32 s58, 1280
    s_mov_b32 s59, 0x00020000
    s_mov_b32 s28, s16
    s_mov_b32 s29, s17
    s_mov_b32 s30, 12591104
    s_mov_b32 s31, 0x00020000
    v_and_b32 v1, 7, v0
    v_lshlrev_b32 v1, 4, v1
    s_lshl_b32 s47, s38, 5
    s_add_u32 s47, s47, s39
    s_lshl_b32 s48, s46, 3
    s_add_u32 s47, s47, s48
    v_lshrrev_b32 v2, 3, v0
    v_add_u32 v2, s47, v2
    v_mul_u32_u24 v3, 0x500, v2
    v_add_u32_e64 v3, v3, v1
    s_waitcnt vmcnt(0)
    s_barrier
    buffer_load_dwordx4 v[24:27], v1, s[56:59], 0 offen offset:0
    buffer_load_dwordx4 v[28:31], v1, s[56:59], 0 offen offset:128
    buffer_load_dwordx4 v[32:35], v1, s[56:59], 0 offen offset:256
    buffer_load_dwordx4 v[36:39], v1, s[56:59], 0 offen offset:384
    buffer_load_dwordx4 v[40:43], v1, s[56:59], 0 offen offset:512
    buffer_load_dwordx4 v[44:47], v1, s[56:59], 0 offen offset:640
    buffer_load_dwordx4 v[48:51], v1, s[56:59], 0 offen offset:768
    buffer_load_dwordx4 v[52:55], v1, s[56:59], 0 offen offset:896
    buffer_load_dwordx4 v[56:59], v1, s[56:59], 0 offen offset:1024
    buffer_load_dwordx4 v[60:63], v1, s[56:59], 0 offen offset:1152
    buffer_load_dwordx4 v[64:67], v3, s[20:23], 0 offen offset:0
    buffer_load_dwordx4 v[68:71], v3, s[20:23], 0 offen offset:128
    buffer_load_dwordx4 v[72:75], v3, s[20:23], 0 offen offset:256
    buffer_load_dwordx4 v[76:79], v3, s[20:23], 0 offen offset:384
    buffer_load_dwordx4 v[80:83], v3, s[20:23], 0 offen offset:512
    buffer_load_dwordx4 v[84:87], v3, s[20:23], 0 offen offset:640
    buffer_load_dwordx4 v[88:91], v3, s[20:23], 0 offen offset:768
    buffer_load_dwordx4 v[92:95], v3, s[20:23], 0 offen offset:896
    buffer_load_dwordx4 v[96:99], v3, s[20:23], 0 offen offset:1024
    buffer_load_dwordx4 v[100:103], v3, s[20:23], 0 offen offset:1152
    v_mov_b32 v9, 0
    v_mov_b32 v10, 0
    s_barrier
    s_waitcnt vmcnt(0)
    v_dot2_f32_bf16 v9, v64, v24, v9
    v_dot2_f32_bf16 v10, v65, v25, v10
    v_dot2_f32_bf16 v9, v66, v26, v9
    v_dot2_f32_bf16 v10, v67, v27, v10
    v_dot2_f32_bf16 v9, v68, v28, v9
    v_dot2_f32_bf16 v10, v69, v29, v10
    v_dot2_f32_bf16 v9, v70, v30, v9
    v_dot2_f32_bf16 v10, v71, v31, v10
    v_dot2_f32_bf16 v9, v72, v32, v9
    v_dot2_f32_bf16 v10, v73, v33, v10
    v_dot2_f32_bf16 v9, v74, v34, v9
    v_dot2_f32_bf16 v10, v75, v35, v10
    v_dot2_f32_bf16 v9, v76, v36, v9
    v_dot2_f32_bf16 v10, v77, v37, v10
    v_dot2_f32_bf16 v9, v78, v38, v9
    v_dot2_f32_bf16 v10, v79, v39, v10
    v_dot2_f32_bf16 v9, v80, v40, v9
    v_dot2_f32_bf16 v10, v81, v41, v10
    v_dot2_f32_bf16 v9, v82, v42, v9
    v_dot2_f32_bf16 v10, v83, v43, v10
    v_dot2_f32_bf16 v9, v84, v44, v9
    v_dot2_f32_bf16 v10, v85, v45, v10
    v_dot2_f32_bf16 v9, v86, v46, v9
    v_dot2_f32_bf16 v10, v87, v47, v10
    v_dot2_f32_bf16 v9, v88, v48, v9
    v_dot2_f32_bf16 v10, v89, v49, v10
    v_dot2_f32_bf16 v9, v90, v50, v9
    v_dot2_f32_bf16 v10, v91, v51, v10
    v_dot2_f32_bf16 v9, v92, v52, v9
    v_dot2_f32_bf16 v10, v93, v53, v10
    v_dot2_f32_bf16 v9, v94, v54, v9
    v_dot2_f32_bf16 v10, v95, v55, v10
    v_dot2_f32_bf16 v9, v96, v56, v9
    v_dot2_f32_bf16 v10, v97, v57, v10
    v_dot2_f32_bf16 v9, v98, v58, v9
    v_dot2_f32_bf16 v10, v99, v59, v10
    v_dot2_f32_bf16 v9, v100, v60, v9
    v_dot2_f32_bf16 v10, v101, v61, v10
    v_dot2_f32_bf16 v9, v102, v62, v9
    v_dot2_f32_bf16 v10, v103, v63, v10
    s_nop 0
    s_nop 2
    v_add_f32 v9, v9, v10
    s_nop 1
    v_add_f32_dpp v11, v9, v9 quad_perm:[1,0,3,2] row_mask:0xf bank_mask:0xf
    v_mov_b32 v9, v11
    s_nop 1
    v_add_f32_dpp v11, v9, v9 quad_perm:[2,3,0,1] row_mask:0xf bank_mask:0xf
    v_mov_b32 v9, v11
    s_nop 1
    v_add_f32_dpp v11, v9, v9 row_half_mirror row_mask:0xf bank_mask:0xf
    v_mov_b32_e64 v9, v11
    v_mul_f32 v9, 0xbfb8aa3b, v9
    v_exp_f32 v9, v9
    s_nop 0
    v_add_f32 v9, 1.0, v9
    v_rcp_f32 v9, v9
    v_lshlrev_b32 v2, 2, v2
    v_mov_b32 v3, 0x40000000
    v_cmp_eq_u32 vcc, 0, v1
    s_nop 1
    v_cndmask_b32_e64 v2, v3, v2, vcc
    s_mov_b32 s60, 12582912
    buffer_store_dword v9, v2, s[28:31], s60 offen
    s_endpgm
    s_nop 0
L1_consumer:
    s_mov_b32 s28, s16
    s_mov_b32 s29, s17
    s_mov_b32 s30, 12591104
    s_mov_b32 s31, 0x00020000
    s_and_b32 s46, s3, 1
    s_lshr_b32 s47, s3, 1
    v_lshrrev_b32 v1, 4, v0
    v_and_b32 v2, 15, v0
    v_bfe_u32 v3, v2, 1, 3
    v_xor_b32 v3, v3, v1
    v_lshlrev_b32 v3, 4, v3
    v_lshl_add_u32 v3, v2, 7, v3
    s_lshl_b32 s48, s46, 13
    s_add_u32 s48, s48, 33792
    v_add_u32 v4, s48, v3
    v_xor_b32 v5, 64, v4
    v_lshrrev_b32 v3, 2, v0
    v_mul_u32_u24 v3, 0x420, v3
    v_and_b32_e64 v15, 3, v0
    v_lshl_add_u32 v6, v15, 3, v3
    s_mov_b32 s51, 4294866944
    s_mov_b32 s52, 50176
    v_mov_b32 v112, 0
    v_mov_b32 v113, 0
    v_mov_b32 v114, 0
    v_mov_b32 v115, 0
    v_mov_b32 v116, 0
    v_mov_b32 v117, 0
    v_mov_b32 v118, 0
    v_mov_b32 v119, 0
    v_mov_b32 v120, 0
    v_mov_b32 v121, 0
    v_mov_b32 v122, 0
    v_mov_b32 v123, 0
    v_mov_b32 v124, 0
    v_mov_b32 v125, 0
    v_mov_b32 v126, 0
    v_mov_b32 v127, 0
    v_mov_b32 v128, 0
    v_mov_b32 v129, 0
    v_mov_b32 v130, 0
    v_mov_b32 v131, 0
    v_mov_b32 v132, 0
    v_mov_b32 v133, 0
    v_mov_b32 v134, 0
    v_mov_b32 v135, 0
    v_mov_b32 v136, 0
    v_mov_b32 v137, 0
    v_mov_b32 v138, 0
    v_mov_b32 v139, 0
    v_mov_b32 v140, 0
    v_mov_b32 v141, 0
    v_mov_b32 v142, 0
    v_mov_b32 v143, 0
    v_mov_b32 v144, 0
    v_mov_b32 v145, 0
    v_mov_b32 v146, 0
    v_mov_b32 v147, 0
    v_mov_b32 v148, 0
    v_mov_b32 v149, 0
    v_mov_b32 v150, 0
    v_mov_b32 v151, 0
    v_mov_b32 v152, 0
    v_mov_b32 v153, 0
    v_mov_b32 v154, 0
    v_mov_b32 v155, 0
    v_mov_b32 v156, 0
    v_mov_b32 v157, 0
    v_mov_b32 v158, 0
    v_mov_b32 v159, 0
    v_mov_b32 v160, 0
    v_mov_b32 v161, 0
    v_mov_b32 v162, 0
    v_mov_b32 v163, 0
    v_mov_b32 v164, 0
    v_mov_b32 v165, 0
    v_mov_b32 v166, 0
    v_mov_b32 v167, 0
    v_mov_b32 v168, 0
    v_mov_b32 v169, 0
    v_mov_b32 v170, 0
    v_mov_b32 v171, 0
    v_mov_b32 v172, 0
    v_mov_b32 v173, 0
    v_mov_b32 v174, 0
    v_mov_b32 v175, 0
    v_mov_b32 v176, 0
    v_mov_b32 v177, 0
    v_mov_b32 v178, 0
    v_mov_b32 v179, 0
    v_mov_b32 v180, 0
    v_mov_b32 v181, 0
    v_mov_b32 v182, 0
    v_mov_b32 v183, 0
    v_mov_b32 v184, 0
    v_mov_b32 v185, 0
    v_mov_b32 v186, 0
    v_mov_b32 v187, 0
    v_mov_b32 v188, 0
    v_mov_b32 v189, 0
    v_mov_b32 v190, 0
    v_mov_b32 v191, 0
    v_mov_b32 v192, 0
    v_mov_b32 v193, 0
    v_mov_b32 v194, 0
    v_mov_b32 v195, 0
    v_mov_b32 v196, 0
    v_mov_b32 v197, 0
    v_mov_b32 v198, 0
    v_mov_b32 v199, 0
    v_mov_b32 v200, 0
    v_mov_b32 v201, 0
    v_mov_b32 v202, 0
    v_mov_b32 v203, 0
    v_mov_b32 v204, 0
    v_mov_b32 v205, 0
    v_mov_b32 v206, 0
    v_mov_b32 v207, 0
    v_mov_b32 v208, 0
    v_mov_b32 v209, 0
    v_mov_b32 v210, 0
    v_mov_b32 v211, 0
    v_mov_b32 v212, 0
    v_mov_b32 v213, 0
    v_mov_b32 v214, 0
    v_mov_b32 v215, 0
    v_mov_b32 v216, 0
    v_mov_b32 v217, 0
    v_mov_b32 v218, 0
    v_mov_b32 v219, 0
    v_mov_b32 v220, 0
    v_mov_b32 v221, 0
    v_mov_b32 v222, 0
    v_mov_b32 v223, 0
    v_mov_b32 v224, 0
    v_mov_b32 v225, 0
    v_mov_b32 v226, 0
    v_mov_b32 v227, 0
    v_mov_b32 v228, 0
    v_mov_b32 v229, 0
    v_mov_b32 v230, 0
    v_mov_b32 v231, 0
    v_mov_b32 v232, 0
    v_mov_b32 v233, 0
    v_mov_b32 v234, 0
    v_mov_b32 v235, 0
    v_mov_b32 v236, 0
    v_mov_b32 v237, 0
    v_mov_b32 v238, 0
    v_mov_b32 v239, 0
    s_cmp_eq_u32 s44, 1
    s_cbranch_scc1 L1_ffn
    s_mul_i32 s48, s47, 80
    v_add_u32 v6, s48, v6
    v_add_u32 v3, s48, v3
    v_and_b32_e64 v16, 1, v15
    v_mad_u32_u24 v3, v16, 40, v3
    v_add_u32 v8, 352, v3
    v_lshrrev_b32_e64 v16, 1, v15
    v_mul_u32_u24 v16, 160, v16
    v_add3_u32 v7, v3, v16, 32
    v_lshlrev_b32 v16, 2, v1
    v_sub_u32 v16, v2, v16
    v_mov_b32 v17, 0xf149f2ca
    v_subrev_u32_e64 v18, 0, v16
    v_cmp_gt_u32 vcc, 8, v18
    s_nop 1
    v_cndmask_b32 v240, v17, 0, vcc
    v_cmp_gt_i32 vcc, -8, v18
    s_nop 1
    v_cndmask_b32 v244, v17, 0, vcc
    v_cmp_le_i32 vcc, 0, v18
    s_nop 1
    v_cndmask_b32 v20, 0, -1, vcc
    v_mov_b32 v250, 0x3f803f80
    v_subrev_u32_e64 v18, 1, v16
    v_cmp_gt_u32 vcc, 8, v18
    s_nop 1
    v_cndmask_b32 v241, v17, 0, vcc
    v_cmp_gt_i32 vcc, -8, v18
    s_nop 1
    v_cndmask_b32 v245, v17, 0, vcc
    v_cmp_le_i32 vcc, 0, v18
    s_nop 1
    v_cndmask_b32 v21, 0, -1, vcc
    v_mov_b32 v251, 0x3f803f80
    v_subrev_u32_e64 v18, 2, v16
    v_cmp_gt_u32 vcc, 8, v18
    s_nop 1
    v_cndmask_b32 v242, v17, 0, vcc
    v_cmp_gt_i32 vcc, -8, v18
    s_nop 1
    v_cndmask_b32 v246, v17, 0, vcc
    v_cmp_le_i32 vcc, 0, v18
    s_nop 1
    v_cndmask_b32 v22, 0, -1, vcc
    v_mov_b32 v252, 0x3f803f80
    v_subrev_u32_e64 v18, 3, v16
    v_cmp_gt_u32 vcc, 8, v18
    s_nop 1
    v_cndmask_b32 v243, v17, 0, vcc
    v_cmp_gt_i32 vcc, -8, v18
    s_nop 1
    v_cndmask_b32 v247, v17, 0, vcc
    v_cmp_le_i32 vcc, 0, v18
    s_nop 1
    v_cndmask_b32 v23, 0, -1, vcc
    v_mov_b32 v253, 0x3f803f80
    v_mov_b32 v17, 0xffff
    v_bfi_b32 v248, v17, v20, v21
    v_bfi_b32 v249, v17, v22, v23
    s_mul_i32 s55, s37, 57
    s_cmp_eq_u32 s37, 0
    s_cselect_b32 s53, 0, 7
    s_mov_b32 s54, 278528
    s_lshl_b32 s58, s38, 1
    s_add_u32 s58, s58, s47
    s_lshl_b32 s58, s58, 12
    s_lshl_b32 s59, s46, 10
    s_add_u32 s58, s58, s59
    v_lshlrev_b32 v19, 8, v1
    v_add_u32 v16, 0, v2
    v_add_u32 v17, s55, v16
    v_lshrrev_b32 v18, 5, v17
    v_mul_u32_u24 v9, s54, v18
    v_and_b32 v18, 16, v17
    v_lshl_add_u32 v9, v18, 7, v9
    v_and_b32_e64 v18, 15, v17
    v_lshl_add_u32 v9, v18, 4, v9
    v_cmp_gt_u32 vcc, 0x400, v17
    v_cmp_le_u32 s[56:57], s53, v16
    s_and_b64 vcc, vcc, s[56:57]
    v_mov_b32 v18, 0x40000000
    v_cndmask_b32 v9, v18, v9, vcc
    v_add_u32 v9, v19, v9
    v_add_u32 v16, 16, v2
    v_add_u32 v17, s55, v16
    v_lshrrev_b32 v18, 5, v17
    v_mul_u32_u24 v10, s54, v18
    v_and_b32_e64 v18, 16, v17
    v_lshl_add_u32 v10, v18, 7, v10
    v_and_b32_e64 v18, 15, v17
    v_lshl_add_u32 v10, v18, 4, v10
    v_cmp_gt_u32 vcc, 0x400, v17
    v_cmp_le_u32 s[56:57], s53, v16
    s_and_b64 vcc, vcc, s[56:57]
    v_mov_b32 v18, 0x40000000
    v_cndmask_b32 v10, v18, v10, vcc
    v_add_u32 v10, v19, v10
    v_add_u32 v16, 32, v2
    v_add_u32 v17, s55, v16
    v_lshrrev_b32 v18, 5, v17
    v_mul_u32_u24 v11, s54, v18
    v_and_b32_e64 v18, 16, v17
    v_lshl_add_u32 v11, v18, 7, v11
    v_and_b32_e64 v18, 15, v17
    v_lshl_add_u32 v11, v18, 4, v11
    v_cmp_gt_u32 vcc, 0x400, v17
    v_cmp_le_u32 s[56:57], s53, v16
    s_and_b64 vcc, vcc, s[56:57]
    v_mov_b32 v18, 0x40000000
    v_cndmask_b32 v11, v18, v11, vcc
    v_add_u32 v11, v19, v11
    v_add_u32 v16, 48, v2
    v_add_u32 v17, s55, v16
    v_lshrrev_b32 v18, 5, v17
    v_mul_u32_u24 v12, s54, v18
    v_and_b32_e64 v18, 16, v17
    v_lshl_add_u32 v12, v18, 7, v12
    v_and_b32_e64 v18, 15, v17
    v_lshl_add_u32 v12, v18, 4, v12
    v_cmp_gt_u32 vcc, 0x400, v17
    v_cmp_le_u32 s[56:57], s53, v16
    s_and_b64 vcc, vcc, s[56:57]
    v_mov_b32 v18, 0x40000000
    v_cndmask_b32 v12, v18, v12, vcc
    v_add_u32 v12, v19, v12
    s_lshr_b32 s60, s38, 1
    s_add_u32 s60, s60, 16
    s_lshl_b32 s60, s60, 12
    s_add_u32 s59, s59, s60
    s_and_b32 s60, s38, 1
    s_lshl_b32 s60, s60, 1
    s_add_u32 s60, s60, s47
    s_lshl_b32 s60, s60, 8
    s_add_u32 s59, s59, s60
    v_and_b32 v19, 1, v1
    v_lshlrev_b32 v19, 3, v19
    v_lshrrev_b32 v20, 1, v1
    v_lshl_add_u32 v20, v20, 4, v2
    v_add_u32 v16, 0, v20
    v_add_u32 v17, s55, v16
    v_lshrrev_b32 v18, 5, v17
    v_mul_u32_u24 v13, s54, v18
    v_and_b32_e64 v18, 16, v17
    v_lshl_add_u32 v13, v18, 7, v13
    v_and_b32_e64 v18, 15, v17
    v_lshl_add_u32 v13, v18, 4, v13
    v_cmp_gt_u32 vcc, 0x400, v17
    v_cmp_le_u32 s[56:57], s53, v16
    s_and_b64 vcc, vcc, s[56:57]
    v_mov_b32 v18, 0x40000000
    v_cndmask_b32 v13, v18, v13, vcc
    v_add_u32 v13, v19, v13
    v_add_u32 v16, 32, v20
    v_add_u32 v17, s55, v16
    v_lshrrev_b32 v18, 5, v17
    v_mul_u32_u24 v14, s54, v18
    v_and_b32_e64 v18, 16, v17
    v_lshl_add_u32 v14, v18, 7, v14
    v_and_b32_e64 v18, 15, v17
    v_lshl_add_u32 v14, v18, 4, v14
    v_cmp_gt_u32 vcc, 0x400, v17
    v_cmp_le_u32 s[56:57], s53, v16
    s_and_b64 vcc, vcc, s[56:57]
    v_mov_b32 v18, 0x40000000
    v_cndmask_b32 v14, v18, v14, vcc
    v_add_u32 v14, v19, v14
    s_mov_b32 s64, 0xffff
    s_mov_b32 s65, 0x0
    s_mov_b32 s66, 0xffff0000
    s_mov_b32 s67, 0x0
    s_mov_b32 s68, 0x0
    s_mov_b32 s69, 0xffff
    s_mov_b32 s70, 0x0
    s_mov_b32 s71, 0xffff0000
    s_mov_b32 s62, 0x3ea52b5c
    s_mov_b32 s63, 0xbea52b5c
    s_nop 0
    s_barrier
    ds_read_b64_tr_b16 v[32:33], v6 offset:0
    ds_read_b64_tr_b16 v[34:35], v6 offset:512
    ds_read_b128 v[16:19], v4 offset:0
    ds_read_b128 v[20:23], v4 offset:2048
    ds_read_b128 v[24:27], v4 offset:4096
    ds_read_b128 v[28:31], v4 offset:6144
    ds_read_b64_tr_b16 v[36:37], v6 offset:40
    ds_read_b64_tr_b16 v[38:39], v6 offset:552
    ds_read_b64_tr_b16 v[40:41], v6 offset:160
    ds_read_b64_tr_b16 v[42:43], v6 offset:672
    ds_read_b64_tr_b16 v[44:45], v6 offset:200
    ds_read_b64_tr_b16 v[46:47], v6 offset:712
    ds_read_b64_tr_b16 v[48:49], v7 offset:0
    ds_read_b64_tr_b16 v[50:51], v7 offset:512
    ds_read_b64_tr_b16 v[52:53], v6 offset:320
    ds_read_b64_tr_b16 v[54:55], v6 offset:832
    ds_read_b64_tr_b16 v[56:57], v6 offset:360
    ds_read_b64_tr_b16 v[58:59], v6 offset:872
    ds_read_b64_tr_b16 v[60:61], v8 offset:0
    ds_read_b64_tr_b16 v[62:63], v8 offset:512
    s_nop 0
    s_mov_b32 s48, 0
    s_mov_b32 s49, 0
    s_waitcnt lgkmcnt(0)
L_att_loop:
    v_mfma_f32_16x16x32_bf16 v[112:115], v[32:35], v[16:19], v[112:115]
    ds_read_b64_tr_b16 v[80:81], v6 offset:16896
    v_mfma_f32_16x16x32_bf16 v[144:147], v[32:35], v[20:23], v[144:147]
    ds_read_b64_tr_b16 v[82:83], v6 offset:17408
    v_mfma_f32_16x16x32_bf16 v[176:179], v[32:35], v[24:27], v[176:179]
    ds_read_b128 v[64:67], v5 offset:0
    v_mfma_f32_16x16x32_bf16 v[208:211], v[32:35], v[28:31], v[208:211]
    ds_read_b128 v[68:71], v5 offset:2048
    v_mfma_f32_16x16x32_bf16 v[116:119], v[36:39], v[16:19], v[116:119]
    ds_read_b128 v[72:75], v5 offset:4096
    v_mfma_f32_16x16x32_bf16 v[148:151], v[36:39], v[20:23], v[148:151]
    ds_read_b128 v[76:79], v5 offset:6144
    v_mfma_f32_16x16x32_bf16 v[180:183], v[36:39], v[24:27], v[180:183]
    ds_read_b64_tr_b16 v[84:85], v6 offset:16936
    v_mfma_f32_16x16x32_bf16 v[212:215], v[36:39], v[28:31], v[212:215]
    ds_read_b64_tr_b16 v[86:87], v6 offset:17448
    v_mfma_f32_16x16x32_bf16 v[120:123], v[40:43], v[16:19], v[120:123]
    ds_read_b64_tr_b16 v[88:89], v6 offset:17056
    v_mfma_f32_16x16x32_bf16 v[152:155], v[40:43], v[20:23], v[152:155]
    ds_read_b64_tr_b16 v[90:91], v6 offset:17568
    v_mfma_f32_16x16x32_bf16 v[184:187], v[40:43], v[24:27], v[184:187]
    ds_read_b64_tr_b16 v[92:93], v6 offset:17096
    v_mfma_f32_16x16x32_bf16 v[216:219], v[40:43], v[28:31], v[216:219]
    ds_read_b64_tr_b16 v[94:95], v6 offset:17608
    v_mfma_f32_16x16x32_bf16 v[124:127], v[44:47], v[16:19], v[124:127]
    ds_read_b64_tr_b16 v[96:97], v7 offset:16896
    v_mfma_f32_16x16x32_bf16 v[156:159], v[44:47], v[20:23], v[156:159]
    ds_read_b64_tr_b16 v[98:99], v7 offset:17408
    v_mfma_f32_16x16x32_bf16 v[188:191], v[44:47], v[24:27], v[188:191]
    ds_read_b64_tr_b16 v[100:101], v6 offset:17216
    v_mfma_f32_16x16x32_bf16 v[220:223], v[44:47], v[28:31], v[220:223]
    ds_read_b64_tr_b16 v[102:103], v6 offset:17728
    v_mfma_f32_16x16x32_bf16 v[128:131], v[48:51], v[16:19], v[128:131]
    ds_read_b64_tr_b16 v[104:105], v6 offset:17256
    v_mfma_f32_16x16x32_bf16 v[160:163], v[48:51], v[20:23], v[160:163]
    ds_read_b64_tr_b16 v[106:107], v6 offset:17768
    v_mfma_f32_16x16x32_bf16 v[192:195], v[48:51], v[24:27], v[192:195]
    ds_read_b64_tr_b16 v[108:109], v8 offset:16896
    v_mfma_f32_16x16x32_bf16 v[224:227], v[48:51], v[28:31], v[224:227]
    ds_read_b64_tr_b16 v[110:111], v8 offset:17408
    v_mfma_f32_16x16x32_bf16 v[132:135], v[16:19], v[52:55], v[132:135]
    s_add_u32 s49, s49, 1
    s_cmp_eq_u32 s49, 3
    v_mfma_f32_16x16x32_bf16 v[164:167], v[20:23], v[52:55], v[164:167]
    s_cselect_b32 s50, s51, s52
    s_cselect_b32 s49, 0, s49
    v_mfma_f32_16x16x32_bf16 v[196:199], v[24:27], v[52:55], v[196:199]
    v_add_u32_e64 v4, s50, v4
    v_mfma_f32_16x16x32_bf16 v[228:231], v[28:31], v[52:55], v[228:231]
    v_add_u32_e64 v5, s50, v5
    v_mfma_f32_16x16x32_bf16 v[136:139], v[16:19], v[56:59], v[136:139]
    v_add_u32_e64 v6, s50, v6
    v_mfma_f32_16x16x32_bf16 v[168:171], v[20:23], v[56:59], v[168:171]
    v_add_u32_e64 v7, s50, v7
    v_mfma_f32_16x16x32_bf16 v[200:203], v[24:27], v[56:59], v[200:203]
    v_add_u32_e64 v8, s50, v8
    v_mfma_f32_16x16x32_bf16 v[232:235], v[28:31], v[56:59], v[232:235]
    v_mfma_f32_16x16x32_bf16 v[140:143], v[16:19], v[60:63], v[140:143]
    v_mfma_f32_16x16x32_bf16 v[172:175], v[20:23], v[60:63], v[172:175]
    v_mfma_f32_16x16x32_bf16 v[204:207], v[24:27], v[60:63], v[204:207]
    v_mfma_f32_16x16x32_bf16 v[236:239], v[28:31], v[60:63], v[236:239]
    s_waitcnt lgkmcnt(0)
    s_barrier
    v_mfma_f32_16x16x32_bf16 v[112:115], v[80:83], v[64:67], v[112:115]
    ds_read_b64_tr_b16 v[32:33], v6 offset:0
    v_mfma_f32_16x16x32_bf16 v[144:147], v[80:83], v[68:71], v[144:147]
    ds_read_b64_tr_b16 v[34:35], v6 offset:512
    v_mfma_f32_16x16x32_bf16 v[176:179], v[80:83], v[72:75], v[176:179]
    ds_read_b128 v[16:19], v4 offset:0
    v_mfma_f32_16x16x32_bf16 v[208:211], v[80:83], v[76:79], v[208:211]
    ds_read_b128 v[20:23], v4 offset:2048
    v_mfma_f32_16x16x32_bf16 v[116:119], v[84:87], v[64:67], v[116:119]
    ds_read_b128 v[24:27], v4 offset:4096
    v_mfma_f32_16x16x32_bf16 v[148:151], v[84:87], v[68:71], v[148:151]
    ds_read_b128 v[28:31], v4 offset:6144
    v_mfma_f32_16x16x32_bf16 v[180:183], v[84:87], v[72:75], v[180:183]
    ds_read_b64_tr_b16 v[36:37], v6 offset:40
    v_mfma_f32_16x16x32_bf16 v[212:215], v[84:87], v[76:79], v[212:215]
    ds_read_b64_tr_b16 v[38:39], v6 offset:552
    v_mfma_f32_16x16x32_bf16 v[120:123], v[88:91], v[64:67], v[120:123]
    ds_read_b64_tr_b16 v[40:41], v6 offset:160
    v_mfma_f32_16x16x32_bf16 v[152:155], v[88:91], v[68:71], v[152:155]
    ds_read_b64_tr_b16 v[42:43], v6 offset:672
    v_mfma_f32_16x16x32_bf16 v[184:187], v[88:91], v[72:75], v[184:187]
    ds_read_b64_tr_b16 v[44:45], v6 offset:200
    v_mfma_f32_16x16x32_bf16 v[216:219], v[88:91], v[76:79], v[216:219]
    ds_read_b64_tr_b16 v[46:47], v6 offset:712
    v_mfma_f32_16x16x32_bf16 v[124:127], v[92:95], v[64:67], v[124:127]
    ds_read_b64_tr_b16 v[48:49], v7 offset:0
    v_mfma_f32_16x16x32_bf16 v[156:159], v[92:95], v[68:71], v[156:159]
    ds_read_b64_tr_b16 v[50:51], v7 offset:512
    v_mfma_f32_16x16x32_bf16 v[188:191], v[92:95], v[72:75], v[188:191]
    ds_read_b64_tr_b16 v[52:53], v6 offset:320
    v_mfma_f32_16x16x32_bf16 v[220:223], v[92:95], v[76:79], v[220:223]
    ds_read_b64_tr_b16 v[54:55], v6 offset:832
    v_mfma_f32_16x16x32_bf16 v[128:131], v[96:99], v[64:67], v[128:131]
    ds_read_b64_tr_b16 v[56:57], v6 offset:360
    v_mfma_f32_16x16x32_bf16 v[160:163], v[96:99], v[68:71], v[160:163]
    ds_read_b64_tr_b16 v[58:59], v6 offset:872
    v_mfma_f32_16x16x32_bf16 v[192:195], v[96:99], v[72:75], v[192:195]
    ds_read_b64_tr_b16 v[60:61], v8 offset:0
    v_mfma_f32_16x16x32_bf16 v[224:227], v[96:99], v[76:79], v[224:227]
    ds_read_b64_tr_b16 v[62:63], v8 offset:512
    v_mfma_f32_16x16x32_bf16 v[132:135], v[64:67], v[100:103], v[132:135]
    s_add_u32 s48, s48, 1
    s_cmp_lt_u32 s48, 10
    v_mfma_f32_16x16x32_bf16 v[164:167], v[68:71], v[100:103], v[164:167]
    v_mfma_f32_16x16x32_bf16 v[196:199], v[72:75], v[100:103], v[196:199]
    v_mfma_f32_16x16x32_bf16 v[228:231], v[76:79], v[100:103], v[228:231]
    v_mfma_f32_16x16x32_bf16 v[136:139], v[64:67], v[104:107], v[136:139]
    v_mfma_f32_16x16x32_bf16 v[168:171], v[68:71], v[104:107], v[168:171]
    v_mfma_f32_16x16x32_bf16 v[200:203], v[72:75], v[104:107], v[200:203]
    v_mfma_f32_16x16x32_bf16 v[232:235], v[76:79], v[104:107], v[232:235]
    v_mfma_f32_16x16x32_bf16 v[140:143], v[64:67], v[108:111], v[140:143]
    v_mfma_f32_16x16x32_bf16 v[172:175], v[68:71], v[108:111], v[172:175]
    v_mfma_f32_16x16x32_bf16 v[204:207], v[72:75], v[108:111], v[204:207]
    v_mfma_f32_16x16x32_bf16 v[236:239], v[76:79], v[108:111], v[236:239]
    s_waitcnt lgkmcnt(0)
    s_cbranch_scc1 L_att_loop
    v_cvt_pk_bf16_f32 v44, v128, v129
    v_cvt_pk_bf16_f32 v45, v130, v131
    v_cvt_pk_bf16_f32 v18, v128, v129
    v_cvt_pk_bf16_f32 v19, v130, v131
    v_cvt_pk_bf16_f32 v40, v112, v113
    v_cvt_pk_bf16_f32 v41, v114, v115
    v_cvt_pk_bf16_f32 v46, v116, v117
    v_cvt_pk_bf16_f32 v47, v118, v119
    v_permlane32_swap_b32 v44, v18
    v_permlane32_swap_b32 v45, v19
    v_cvt_pk_bf16_f32 v16, v120, v121
    v_cvt_pk_bf16_f32 v17, v122, v123
    v_cvt_pk_bf16_f32 v20, v124, v125
    v_cvt_pk_bf16_f32 v21, v126, v127
    v_cndmask_b32 v42, 0, v44, s[64:65]
    v_cndmask_b32 v44, 0, v44, s[66:67]
    v_cndmask_b32 v43, 0, v45, s[64:65]
    v_cndmask_b32 v45, 0, v45, s[66:67]
    v_cvt_pk_bf16_f32 v52, v160, v161
    v_cvt_pk_bf16_f32 v53, v162, v163
    v_cvt_pk_bf16_f32 v24, v160, v161
    v_cvt_pk_bf16_f32 v25, v162, v163
    v_cvt_pk_bf16_f32 v48, v144, v145
    v_cvt_pk_bf16_f32 v49, v146, v147
    v_cvt_pk_bf16_f32 v54, v148, v149
    v_cvt_pk_bf16_f32 v55, v150, v151
    v_permlane32_swap_b32 v52, v24
    v_permlane32_swap_b32 v53, v25
    v_cvt_pk_bf16_f32 v22, v152, v153
    v_cvt_pk_bf16_f32 v23, v154, v155
    v_cvt_pk_bf16_f32 v26, v156, v157
    v_cvt_pk_bf16_f32 v27, v158, v159
    v_cndmask_b32 v50, 0, v52, s[64:65]
    v_cndmask_b32 v52, 0, v52, s[66:67]
    v_cndmask_b32 v51, 0, v53, s[64:65]
    v_cndmask_b32 v53, 0, v53, s[66:67]
    v_cvt_pk_bf16_f32 v60, v192, v193
    v_cvt_pk_bf16_f32 v61, v194, v195
    v_cvt_pk_bf16_f32 v30, v192, v193
    v_cvt_pk_bf16_f32 v31, v194, v195
    v_cvt_pk_bf16_f32 v56, v176, v177
    v_cvt_pk_bf16_f32 v57, v178, v179
    v_cvt_pk_bf16_f32 v62, v180, v181
    v_cvt_pk_bf16_f32 v63, v182, v183
    v_permlane32_swap_b32 v60, v30
    v_permlane32_swap_b32 v61, v31
    v_cvt_pk_bf16_f32 v28, v184, v185
    v_cvt_pk_bf16_f32 v29, v186, v187
    v_cvt_pk_bf16_f32 v32, v188, v189
    v_cvt_pk_bf16_f32 v33, v190, v191
    v_cndmask_b32 v58, 0, v60, s[64:65]
    v_cndmask_b32 v60, 0, v60, s[66:67]
    v_cndmask_b32 v59, 0, v61, s[64:65]
    v_cndmask_b32 v61, 0, v61, s[66:67]
    v_cvt_pk_bf16_f32 v68, v224, v225
    v_cvt_pk_bf16_f32 v69, v226, v227
    v_cvt_pk_bf16_f32 v36, v224, v225
    v_cvt_pk_bf16_f32 v37, v226, v227
    v_cvt_pk_bf16_f32 v64, v208, v209
    v_cvt_pk_bf16_f32 v65, v210, v211
    v_cvt_pk_bf16_f32 v70, v212, v213
    v_cvt_pk_bf16_f32 v71, v214, v215
    v_permlane32_swap_b32 v68, v36
    v_permlane32_swap_b32 v69, v37
    v_cvt_pk_bf16_f32 v34, v216, v217
    v_cvt_pk_bf16_f32 v35, v218, v219
    v_cvt_pk_bf16_f32 v38, v220, v221
    v_cvt_pk_bf16_f32 v39, v222, v223
    v_cndmask_b32 v66, 0, v68, s[64:65]
    v_cndmask_b32 v68, 0, v68, s[66:67]
    v_cndmask_b32 v67, 0, v69, s[64:65]
    v_cndmask_b32 v69, 0, v69, s[66:67]
    v_cvt_pk_bf16_f32 v72, v132, v133
    v_cvt_pk_bf16_f32 v73, v134, v135
    v_cvt_pk_bf16_f32 v80, v136, v137
    v_cvt_pk_bf16_f32 v81, v138, v139
    v_cvt_pk_bf16_f32 v88, v140, v141
    v_cvt_pk_bf16_f32 v89, v142, v143
    v_cvt_pk_bf16_f32 v74, v164, v165
    v_cvt_pk_bf16_f32 v75, v166, v167
    v_cvt_pk_bf16_f32 v82, v168, v169
    v_cvt_pk_bf16_f32 v83, v170, v171
    v_cvt_pk_bf16_f32 v90, v172, v173
    v_cvt_pk_bf16_f32 v91, v174, v175
    v_mfma_f32_16x16x32_bf16 v[112:115], v[16:19], v[40:43], v[240:243]
    v_cvt_pk_bf16_f32 v76, v196, v197
    v_mfma_f32_16x16x32_bf16 v[120:123], v[22:25], v[48:51], v[240:243]
    v_cvt_pk_bf16_f32 v77, v198, v199
    v_mfma_f32_16x16x32_bf16 v[124:127], v[16:19], v[48:51], v[244:247]
    v_cvt_pk_bf16_f32 v84, v200, v201
    v_mfma_f32_16x16x32_bf16 v[128:131], v[28:31], v[56:59], v[240:243]
    v_cvt_pk_bf16_f32 v85, v202, v203
    v_mfma_f32_16x16x32_bf16 v[132:135], v[22:25], v[56:59], v[244:247]
    v_cvt_pk_bf16_f32 v92, v204, v205
    v_mfma_f32_16x16x32_bf16 v[136:139], v[34:37], v[64:67], v[240:243]
    v_cvt_pk_bf16_f32 v93, v206, v207
    v_mfma_f32_16x16x32_bf16 v[140:143], v[28:31], v[64:67], v[244:247]
    v_cvt_pk_bf16_f32 v78, v228, v229
    v_mfma_f32_16x16x32_bf16 v[144:147], v[18:21], v[44:47], v[240:243]
    v_cvt_pk_bf16_f32 v79, v230, v231
    v_mfma_f32_16x16x32_bf16 v[152:155], v[24:27], v[52:55], v[240:243]
    v_cvt_pk_bf16_f32 v86, v232, v233
    v_mfma_f32_16x16x32_bf16 v[156:159], v[18:21], v[52:55], v[244:247]
    v_cvt_pk_bf16_f32 v87, v234, v235
    v_mfma_f32_16x16x32_bf16 v[160:163], v[30:33], v[60:63], v[240:243]
    v_cvt_pk_bf16_f32 v94, v236, v237
    v_mfma_f32_16x16x32_bf16 v[164:167], v[24:27], v[60:63], v[244:247]
    v_cvt_pk_bf16_f32 v95, v238, v239
    v_mfma_f32_16x16x32_bf16 v[168:171], v[36:39], v[68:71], v[240:243]
    v_mfma_f32_16x16x32_bf16 v[172:175], v[30:33], v[68:71], v[244:247]
    v_max3_f32 v96, v112, v113, v114
    v_max_f32 v96, v96, v115
    v_max_f32 v120, v120, v124
    v_max_f32 v121, v121, v125
    v_max_f32 v122, v122, v126
    v_max_f32_e64 v123, v123, v127
    v_max3_f32 v97, v120, v121, v122
    v_max_f32 v97, v97, v123
    v_max_f32 v128, v128, v132
    v_max_f32 v129, v129, v133
    v_max_f32 v130, v130, v134
    v_max_f32_e64 v131, v131, v135
    v_max3_f32 v98, v128, v129, v130
    v_max_f32 v98, v98, v131
    v_max_f32 v136, v136, v140
    v_max_f32 v137, v137, v141
    v_max_f32 v138, v138, v142
    v_max_f32_e64 v139, v139, v143
    v_max3_f32 v99, v136, v137, v138
    v_max_f32_e64 v99, v99, v139
    v_max3_f32 v100, v144, v145, v146
    v_max_f32 v100, v100, v147
    v_max_f32 v152, v152, v156
    v_max_f32 v153, v153, v157
    v_max_f32 v154, v154, v158
    v_max_f32_e64 v155, v155, v159
    v_max3_f32 v101, v152, v153, v154
    v_max_f32 v101, v101, v155
    v_max_f32 v160, v160, v164
    v_max_f32 v161, v161, v165
    v_max_f32 v162, v162, v166
    v_max_f32_e64 v163, v163, v167
    v_max3_f32 v102, v160, v161, v162
    v_max_f32 v102, v102, v163
    v_max_f32 v168, v168, v172
    v_max_f32 v169, v169, v173
    v_max_f32 v170, v170, v174
    v_max_f32_e64 v171, v171, v175
    v_max3_f32 v103, v168, v169, v170
    v_max_f32 v103, v103, v171
    v_permlane32_swap_b32 v96, v97
    v_permlane32_swap_b32 v98, v99
    v_permlane32_swap_b32 v100, v101
    v_permlane32_swap_b32 v102, v103
    v_max_f32 v96, v96, v97
    v_max_f32 v98, v98, v99
    v_max_f32 v100, v100, v101
    v_max_f32 v102, v102, v103
    v_permlane16_swap_b32 v96, v98
    s_nop 0
    v_permlane16_swap_b32 v100, v102
    v_max_f32 v96, v96, v98
    v_max_f32 v100, v100, v102
    v_mul_f32 v98, s63, v96
    v_mul_f32 v102, s63, v100
    v_mul_f32 v96, s63, v96
    v_mul_f32 v100, s63, v100
    s_nop 0
    v_permlane16_swap_b32 v96, v98
    v_permlane16_swap_b32 v100, v102
    v_mov_b32 v97, v96
    v_mov_b32 v99, v98
    v_mov_b32 v101, v100
    v_mov_b32 v103, v102
    v_permlane32_swap_b32 v96, v97
    v_permlane32_swap_b32 v98, v99
    v_permlane32_swap_b32 v100, v101
    v_permlane32_swap_b32_e64 v102, v103
    v_fma_f32 v112, v112, s62, v96
    v_fma_f32 v113, v113, s62, v96
    v_fma_f32 v114, v114, s62, v96
    v_fma_f32 v115, v115, s62, v96
    v_exp_f32 v112, v112
    v_exp_f32 v113, v113
    v_exp_f32 v114, v114
    v_exp_f32 v115, v115
    v_cvt_pk_bf16_f32 v178, v112, v113
    v_cvt_pk_bf16_f32 v179, v114, v115
    v_fma_f32 v120, v120, s62, v97
    v_fma_f32 v121, v121, s62, v97
    v_fma_f32 v122, v122, s62, v97
    v_fma_f32 v123, v123, s62, v97
    v_exp_f32_e64 v120, v120
    v_mfma_f32_16x16x16_bf16 v[208:211], v[250:251], v[178:179], 0
    v_exp_f32_e64 v121, v121
    v_mfma_f32_16x16x16_bf16 v[112:115], v[72:73], v[178:179], 0
    v_exp_f32_e64 v122, v122
    v_mfma_f32_16x16x16_bf16 v[116:119], v[88:89], v[178:179], 0
    v_exp_f32_e64 v123, v123
    v_cvt_pk_bf16_f32 v180, v120, v121
    v_cvt_pk_bf16_f32 v181, v122, v123
    v_and_b32 v182, v248, v180
    v_and_b32 v183, v249, v181
    v_bfi_b32 v180, v248, 0, v180
    v_bfi_b32 v181, v249, 0, v181
    v_fma_f32 v128, v128, s62, v98
    v_fma_f32 v129, v129, s62, v98
    v_fma_f32 v130, v130, s62, v98
    v_fma_f32 v131, v131, s62, v98
    v_exp_f32_e64 v128, v128
    v_mfma_f32_16x16x32_bf16 v[212:215], v[250:253], v[180:183], 0
    v_exp_f32_e64 v129, v129
    v_mfma_f32_16x16x32_bf16 v[120:123], v[72:75], v[180:183], 0
    v_exp_f32_e64 v130, v130
    v_mfma_f32_16x16x32_bf16 v[124:127], v[88:91], v[180:183], 0
    v_exp_f32_e64 v131, v131
    v_cvt_pk_bf16_f32 v184, v128, v129
    v_cvt_pk_bf16_f32 v185, v130, v131
    v_and_b32 v186, v248, v184
    v_and_b32 v187, v249, v185
    v_bfi_b32 v184, v248, 0, v184
    v_bfi_b32 v185, v249, 0, v185
    v_fma_f32 v136, v136, s62, v99
    v_fma_f32 v137, v137, s62, v99
    v_fma_f32 v138, v138, s62, v99
    v_fma_f32 v139, v139, s62, v99
    v_exp_f32_e64 v136, v136
    v_mfma_f32_16x16x32_bf16 v[216:219], v[250:253], v[184:187], 0
    v_exp_f32_e64 v137, v137
    v_mfma_f32_16x16x32_bf16 v[128:131], v[74:77], v[184:187], 0
    v_exp_f32_e64 v138, v138
    v_mfma_f32_16x16x32_bf16 v[132:135], v[90:93], v[184:187], 0
    v_exp_f32_e64 v139, v139
    v_cvt_pk_bf16_f32 v188, v136, v137
    v_cvt_pk_bf16_f32 v189, v138, v139
    v_and_b32 v190, v248, v188
    v_and_b32 v191, v249, v189
    v_bfi_b32 v188, v248, 0, v188
    v_bfi_b32 v189, v249, 0, v189
    v_fma_f32 v144, v144, s62, v100
    v_fma_f32 v145, v145, s62, v100
    v_fma_f32 v146, v146, s62, v100
    v_fma_f32 v147, v147, s62, v100
    v_exp_f32_e64 v144, v144
    v_mfma_f32_16x16x32_bf16 v[220:223], v[250:253], v[188:191], 0
    v_exp_f32_e64 v145, v145
    v_mfma_f32_16x16x32_bf16 v[136:139], v[76:79], v[188:191], 0
    v_exp_f32_e64 v146, v146
    v_mfma_f32_16x16x32_bf16 v[140:143], v[92:95], v[188:191], 0
    v_exp_f32_e64 v147, v147
    v_cvt_pk_bf16_f32 v194, v144, v145
    v_cvt_pk_bf16_f32 v195, v146, v147
    v_fma_f32 v152, v152, s62, v101
    v_fma_f32 v153, v153, s62, v101
    v_fma_f32 v154, v154, s62, v101
    v_fma_f32 v155, v155, s62, v101
    v_exp_f32_e64 v152, v152
    v_mfma_f32_16x16x16_bf16 v[224:227], v[250:251], v[194:195], 0
    v_exp_f32_e64 v153, v153
    v_mfma_f32_16x16x16_bf16 v[144:147], v[80:81], v[194:195], 0
    v_exp_f32_e64 v154, v154
    v_mfma_f32_16x16x16_bf16 v[148:151], v[88:89], v[194:195], 0
    v_exp_f32_e64 v155, v155
    v_cvt_pk_bf16_f32 v196, v152, v153
    v_cvt_pk_bf16_f32 v197, v154, v155
    v_and_b32 v198, v248, v196
    v_and_b32 v199, v249, v197
    v_bfi_b32 v196, v248, 0, v196
    v_bfi_b32 v197, v249, 0, v197
    v_fma_f32 v160, v160, s62, v102
    v_fma_f32 v161, v161, s62, v102
    v_fma_f32 v162, v162, s62, v102
    v_fma_f32 v163, v163, s62, v102
    v_exp_f32_e64 v160, v160
    v_mfma_f32_16x16x32_bf16 v[228:231], v[250:253], v[196:199], 0
    v_exp_f32_e64 v161, v161
    v_mfma_f32_16x16x32_bf16 v[152:155], v[80:83], v[196:199], 0
    v_exp_f32_e64 v162, v162
    v_mfma_f32_16x16x32_bf16 v[156:159], v[88:91], v[196:199], 0
    v_exp_f32_e64 v163, v163
    v_cvt_pk_bf16_f32 v200, v160, v161
    v_cvt_pk_bf16_f32 v201, v162, v163
    v_and_b32 v202, v248, v200
    v_and_b32 v203, v249, v201
    v_bfi_b32 v200, v248, 0, v200
    v_bfi_b32 v201, v249, 0, v201
    v_fma_f32 v168, v168, s62, v103
    v_fma_f32 v169, v169, s62, v103
    v_fma_f32 v170, v170, s62, v103
    v_fma_f32 v171, v171, s62, v103
    v_exp_f32_e64 v168, v168
    v_mfma_f32_16x16x32_bf16 v[232:235], v[250:253], v[200:203], 0
    v_exp_f32_e64 v169, v169
    v_mfma_f32_16x16x32_bf16 v[160:163], v[82:85], v[200:203], 0
    v_exp_f32_e64 v170, v170
    v_mfma_f32_16x16x32_bf16 v[164:167], v[90:93], v[200:203], 0
    v_exp_f32_e64 v171, v171
    v_cvt_pk_bf16_f32 v204, v168, v169
    v_cvt_pk_bf16_f32 v205, v170, v171
    v_and_b32 v206, v248, v204
    v_and_b32 v207, v249, v205
    v_bfi_b32 v204, v248, 0, v204
    v_bfi_b32 v205, v249, 0, v205
    s_nop 0
    s_nop 1
    v_mfma_f32_16x16x32_bf16 v[236:239], v[250:253], v[204:207], 0
    v_mfma_f32_16x16x32_bf16 v[168:171], v[84:87], v[204:207], 0
    v_mfma_f32_16x16x32_bf16 v[172:175], v[92:95], v[204:207], 0
    v_rcp_f32 v208, v208
    v_rcp_f32 v212, v212
    v_rcp_f32 v216, v216
    v_rcp_f32 v220, v220
    v_rcp_f32 v224, v224
    v_rcp_f32 v228, v228
    v_rcp_f32 v232, v232
    v_rcp_f32 v236, v236
    v_pk_mul_f32 v[112:113], v[112:113], v[208:209] op_sel_hi:[1,0]
    v_pk_mul_f32 v[114:115], v[114:115], v[208:209] op_sel_hi:[1,0]
    v_pk_mul_f32 v[144:145], v[144:145], v[224:225] op_sel_hi:[1,0]
    v_pk_mul_f32 v[146:147], v[146:147], v[224:225] op_sel_hi:[1,0]
    v_cvt_pk_bf16_f32 v16, v112, v113
    v_cvt_pk_bf16_f32 v17, v114, v115
    v_cvt_pk_bf16_f32 v18, v144, v145
    v_cvt_pk_bf16_f32 v19, v146, v147
    buffer_store_dwordx4 v[16:19], v9, s[28:31], s58 offen
    v_pk_mul_f32 v[120:121], v[120:121], v[212:213] op_sel_hi:[1,0]
    v_pk_mul_f32 v[122:123], v[122:123], v[212:213] op_sel_hi:[1,0]
    v_pk_mul_f32 v[152:153], v[152:153], v[228:229] op_sel_hi:[1,0]
    v_pk_mul_f32 v[154:155], v[154:155], v[228:229] op_sel_hi:[1,0]
    v_cvt_pk_bf16_f32 v20, v120, v121
    v_cvt_pk_bf16_f32 v21, v122, v123
    v_cvt_pk_bf16_f32 v22, v152, v153
    v_cvt_pk_bf16_f32 v23, v154, v155
    buffer_store_dwordx4 v[20:23], v10, s[28:31], s58 offen
    v_pk_mul_f32 v[128:129], v[128:129], v[216:217] op_sel_hi:[1,0]
    v_pk_mul_f32 v[130:131], v[130:131], v[216:217] op_sel_hi:[1,0]
    v_pk_mul_f32 v[160:161], v[160:161], v[232:233] op_sel_hi:[1,0]
    v_pk_mul_f32 v[162:163], v[162:163], v[232:233] op_sel_hi:[1,0]
    v_cvt_pk_bf16_f32 v24, v128, v129
    v_cvt_pk_bf16_f32 v25, v130, v131
    v_cvt_pk_bf16_f32 v26, v160, v161
    v_cvt_pk_bf16_f32 v27, v162, v163
    buffer_store_dwordx4 v[24:27], v11, s[28:31], s58 offen
    v_pk_mul_f32 v[136:137], v[136:137], v[220:221] op_sel_hi:[1,0]
    v_pk_mul_f32 v[138:139], v[138:139], v[220:221] op_sel_hi:[1,0]
    v_pk_mul_f32 v[168:169], v[168:169], v[236:237] op_sel_hi:[1,0]
    v_pk_mul_f32 v[170:171], v[170:171], v[236:237] op_sel_hi:[1,0]
    v_cvt_pk_bf16_f32 v28, v136, v137
    v_cvt_pk_bf16_f32 v29, v138, v139
    v_cvt_pk_bf16_f32 v30, v168, v169
    v_cvt_pk_bf16_f32 v31, v170, v171
    buffer_store_dwordx4 v[28:31], v12, s[28:31], s58 offen
    s_nop 0
    s_mov_b64 exec, s[64:65]
    v_pk_mul_f32 v[40:41], v[116:117], v[208:209] op_sel_hi:[1,0]
    v_pk_mul_f32 v[42:43], v[118:119], v[208:209] op_sel_hi:[1,0]
    v_pk_mul_f32 v[44:45], v[132:133], v[216:217] op_sel_hi:[1,0]
    v_pk_mul_f32 v[46:47], v[134:135], v[216:217] op_sel_hi:[1,0]
    s_nop 0
    s_mov_b64 exec, s[66:67]
    v_pk_mul_f32 v[40:41], v[148:149], v[224:225] op_sel_hi:[1,0]
    v_pk_mul_f32 v[42:43], v[150:151], v[224:225] op_sel_hi:[1,0]
    v_pk_mul_f32 v[44:45], v[164:165], v[232:233] op_sel_hi:[1,0]
    v_pk_mul_f32 v[46:47], v[166:167], v[232:233] op_sel_hi:[1,0]
    s_nop 0
    s_mov_b64 exec, s[68:69]
    v_pk_mul_f32 v[40:41], v[124:125], v[212:213] op_sel_hi:[1,0]
    v_pk_mul_f32 v[42:43], v[126:127], v[212:213] op_sel_hi:[1,0]
    v_pk_mul_f32 v[44:45], v[140:141], v[220:221] op_sel_hi:[1,0]
    v_pk_mul_f32 v[46:47], v[142:143], v[220:221] op_sel_hi:[1,0]
    s_nop 0
    s_mov_b64 exec, s[70:71]
    v_pk_mul_f32 v[40:41], v[156:157], v[228:229] op_sel_hi:[1,0]
    v_pk_mul_f32 v[42:43], v[158:159], v[228:229] op_sel_hi:[1,0]
    v_pk_mul_f32 v[44:45], v[172:173], v[236:237] op_sel_hi:[1,0]
    v_pk_mul_f32 v[46:47], v[174:175], v[236:237] op_sel_hi:[1,0]
    s_nop 0
    s_mov_b64 exec, -1
    v_cvt_pk_bf16_f32 v48, v40, v41
    v_cvt_pk_bf16_f32 v49, v42, v43
    buffer_store_dwordx2 v[48:49], v13, s[28:31], s59 offen
    v_cvt_pk_bf16_f32 v50, v44, v45
    v_cvt_pk_bf16_f32 v51, v46, v47
    buffer_store_dwordx2 v[50:51], v14, s[28:31], s59 offen
    s_endpgm
L1_ffn:
    s_lshl_b32 s48, s47, 8
    v_add_u32 v6, s48, v6
    v_lshlrev_b32 v9, 4, v0
    s_mul_i32 s58, s37, 557056
    s_nop 0
    s_lshl_b32 s59, s38, 3
    s_lshl_b32 s60, s47, 2
    s_add_u32 s59, s59, s60
    s_add_u32 s59, s59, 20
    s_lshl_b32 s59, s59, 12
    s_add_u32 s58, s58, s59
    s_lshl_b32 s59, s46, 10
    s_add_u32 s58, s58, s59
    s_barrier
    ds_read_b64_tr_b16 v[32:33], v6 offset:0
    ds_read_b64_tr_b16 v[34:35], v6 offset:512
    ds_read_b128 v[16:19], v4 offset:0
    ds_read_b128 v[20:23], v4 offset:2048
    ds_read_b128 v[24:27], v4 offset:4096
    ds_read_b128 v[28:31], v4 offset:6144
    ds_read_b64_tr_b16 v[36:37], v6 offset:32
    ds_read_b64_tr_b16 v[38:39], v6 offset:544
    ds_read_b64_tr_b16 v[40:41], v6 offset:64
    ds_read_b64_tr_b16 v[42:43], v6 offset:576
    ds_read_b64_tr_b16 v[44:45], v6 offset:96
    ds_read_b64_tr_b16 v[46:47], v6 offset:608
    ds_read_b64_tr_b16 v[48:49], v6 offset:128
    ds_read_b64_tr_b16 v[50:51], v6 offset:640
    ds_read_b64_tr_b16 v[52:53], v6 offset:160
    ds_read_b64_tr_b16 v[54:55], v6 offset:672
    ds_read_b64_tr_b16 v[56:57], v6 offset:192
    ds_read_b64_tr_b16 v[58:59], v6 offset:704
    ds_read_b64_tr_b16 v[60:61], v6 offset:224
    ds_read_b64_tr_b16 v[62:63], v6 offset:736
    s_nop 0
    s_mov_b32 s48, 0
    s_mov_b32 s49, 0
    s_waitcnt lgkmcnt(0)
L_ffn_loop:
    v_mfma_f32_16x16x32_bf16 v[112:115], v[32:35], v[16:19], v[112:115]
    ds_read_b64_tr_b16 v[80:81], v6 offset:16896
    v_mfma_f32_16x16x32_bf16 v[144:147], v[32:35], v[20:23], v[144:147]
    ds_read_b64_tr_b16 v[82:83], v6 offset:17408
    v_mfma_f32_16x16x32_bf16 v[176:179], v[32:35], v[24:27], v[176:179]
    ds_read_b128 v[64:67], v5 offset:0
    v_mfma_f32_16x16x32_bf16 v[208:211], v[32:35], v[28:31], v[208:211]
    ds_read_b128 v[68:71], v5 offset:2048
    v_mfma_f32_16x16x32_bf16 v[116:119], v[36:39], v[16:19], v[116:119]
    ds_read_b128 v[72:75], v5 offset:4096
    v_mfma_f32_16x16x32_bf16 v[148:151], v[36:39], v[20:23], v[148:151]
    ds_read_b128 v[76:79], v5 offset:6144
    v_mfma_f32_16x16x32_bf16 v[180:183], v[36:39], v[24:27], v[180:183]
    ds_read_b64_tr_b16 v[84:85], v6 offset:16928
    v_mfma_f32_16x16x32_bf16 v[212:215], v[36:39], v[28:31], v[212:215]
    ds_read_b64_tr_b16 v[86:87], v6 offset:17440
    v_mfma_f32_16x16x32_bf16 v[120:123], v[40:43], v[16:19], v[120:123]
    ds_read_b64_tr_b16 v[88:89], v6 offset:16960
    v_mfma_f32_16x16x32_bf16 v[152:155], v[40:43], v[20:23], v[152:155]
    ds_read_b64_tr_b16 v[90:91], v6 offset:17472
    v_mfma_f32_16x16x32_bf16 v[184:187], v[40:43], v[24:27], v[184:187]
    ds_read_b64_tr_b16 v[92:93], v6 offset:16992
    v_mfma_f32_16x16x32_bf16 v[216:219], v[40:43], v[28:31], v[216:219]
    ds_read_b64_tr_b16 v[94:95], v6 offset:17504
    v_mfma_f32_16x16x32_bf16 v[124:127], v[44:47], v[16:19], v[124:127]
    ds_read_b64_tr_b16 v[96:97], v6 offset:17024
    v_mfma_f32_16x16x32_bf16 v[156:159], v[44:47], v[20:23], v[156:159]
    ds_read_b64_tr_b16 v[98:99], v6 offset:17536
    v_mfma_f32_16x16x32_bf16 v[188:191], v[44:47], v[24:27], v[188:191]
    ds_read_b64_tr_b16 v[100:101], v6 offset:17056
    v_mfma_f32_16x16x32_bf16 v[220:223], v[44:47], v[28:31], v[220:223]
    ds_read_b64_tr_b16 v[102:103], v6 offset:17568
    v_mfma_f32_16x16x32_bf16 v[128:131], v[48:51], v[16:19], v[128:131]
    ds_read_b64_tr_b16 v[104:105], v6 offset:17088
    v_mfma_f32_16x16x32_bf16 v[160:163], v[48:51], v[20:23], v[160:163]
    ds_read_b64_tr_b16 v[106:107], v6 offset:17600
    v_mfma_f32_16x16x32_bf16 v[192:195], v[48:51], v[24:27], v[192:195]
    ds_read_b64_tr_b16 v[108:109], v6 offset:17120
    v_mfma_f32_16x16x32_bf16 v[224:227], v[48:51], v[28:31], v[224:227]
    ds_read_b64_tr_b16 v[110:111], v6 offset:17632
    v_mfma_f32_16x16x32_bf16 v[132:135], v[52:55], v[16:19], v[132:135]
    s_add_u32 s49, s49, 1
    s_cmp_eq_u32 s49, 3
    v_mfma_f32_16x16x32_bf16 v[164:167], v[52:55], v[20:23], v[164:167]
    s_cselect_b32 s50, s51, s52
    s_cselect_b32 s49, 0, s49
    v_mfma_f32_16x16x32_bf16 v[196:199], v[52:55], v[24:27], v[196:199]
    v_add_u32_e64 v4, s50, v4
    v_mfma_f32_16x16x32_bf16 v[228:231], v[52:55], v[28:31], v[228:231]
    v_add_u32_e64 v5, s50, v5
    v_mfma_f32_16x16x32_bf16 v[136:139], v[56:59], v[16:19], v[136:139]
    v_add_u32_e64 v6, s50, v6
    v_mfma_f32_16x16x32_bf16 v[168:171], v[56:59], v[20:23], v[168:171]
    v_mfma_f32_16x16x32_bf16 v[200:203], v[56:59], v[24:27], v[200:203]
    v_mfma_f32_16x16x32_bf16 v[232:235], v[56:59], v[28:31], v[232:235]
    v_mfma_f32_16x16x32_bf16 v[140:143], v[60:63], v[16:19], v[140:143]
    v_mfma_f32_16x16x32_bf16 v[172:175], v[60:63], v[20:23], v[172:175]
    v_mfma_f32_16x16x32_bf16 v[204:207], v[60:63], v[24:27], v[204:207]
    v_mfma_f32_16x16x32_bf16 v[236:239], v[60:63], v[28:31], v[236:239]
    s_waitcnt lgkmcnt(0)
    s_barrier
    v_mfma_f32_16x16x32_bf16 v[112:115], v[80:83], v[64:67], v[112:115]
    ds_read_b64_tr_b16 v[32:33], v6 offset:0
    v_mfma_f32_16x16x32_bf16 v[144:147], v[80:83], v[68:71], v[144:147]
    ds_read_b64_tr_b16 v[34:35], v6 offset:512
    v_mfma_f32_16x16x32_bf16 v[176:179], v[80:83], v[72:75], v[176:179]
    ds_read_b128 v[16:19], v4 offset:0
    v_mfma_f32_16x16x32_bf16 v[208:211], v[80:83], v[76:79], v[208:211]
    ds_read_b128 v[20:23], v4 offset:2048
    v_mfma_f32_16x16x32_bf16 v[116:119], v[84:87], v[64:67], v[116:119]
    ds_read_b128 v[24:27], v4 offset:4096
    v_mfma_f32_16x16x32_bf16 v[148:151], v[84:87], v[68:71], v[148:151]
    ds_read_b128 v[28:31], v4 offset:6144
    v_mfma_f32_16x16x32_bf16 v[180:183], v[84:87], v[72:75], v[180:183]
    ds_read_b64_tr_b16 v[36:37], v6 offset:32
    v_mfma_f32_16x16x32_bf16 v[212:215], v[84:87], v[76:79], v[212:215]
    ds_read_b64_tr_b16 v[38:39], v6 offset:544
    v_mfma_f32_16x16x32_bf16 v[120:123], v[88:91], v[64:67], v[120:123]
    ds_read_b64_tr_b16 v[40:41], v6 offset:64
    v_mfma_f32_16x16x32_bf16 v[152:155], v[88:91], v[68:71], v[152:155]
    ds_read_b64_tr_b16 v[42:43], v6 offset:576
    v_mfma_f32_16x16x32_bf16 v[184:187], v[88:91], v[72:75], v[184:187]
    ds_read_b64_tr_b16 v[44:45], v6 offset:96
    v_mfma_f32_16x16x32_bf16 v[216:219], v[88:91], v[76:79], v[216:219]
    ds_read_b64_tr_b16 v[46:47], v6 offset:608
    v_mfma_f32_16x16x32_bf16 v[124:127], v[92:95], v[64:67], v[124:127]
    ds_read_b64_tr_b16 v[48:49], v6 offset:128
    v_mfma_f32_16x16x32_bf16 v[156:159], v[92:95], v[68:71], v[156:159]
    ds_read_b64_tr_b16 v[50:51], v6 offset:640
    v_mfma_f32_16x16x32_bf16 v[188:191], v[92:95], v[72:75], v[188:191]
    ds_read_b64_tr_b16 v[52:53], v6 offset:160
    v_mfma_f32_16x16x32_bf16 v[220:223], v[92:95], v[76:79], v[220:223]
    ds_read_b64_tr_b16 v[54:55], v6 offset:672
    v_mfma_f32_16x16x32_bf16 v[128:131], v[96:99], v[64:67], v[128:131]
    ds_read_b64_tr_b16 v[56:57], v6 offset:192
    v_mfma_f32_16x16x32_bf16 v[160:163], v[96:99], v[68:71], v[160:163]
    ds_read_b64_tr_b16 v[58:59], v6 offset:704
    v_mfma_f32_16x16x32_bf16 v[192:195], v[96:99], v[72:75], v[192:195]
    ds_read_b64_tr_b16 v[60:61], v6 offset:224
    v_mfma_f32_16x16x32_bf16 v[224:227], v[96:99], v[76:79], v[224:227]
    ds_read_b64_tr_b16 v[62:63], v6 offset:736
    v_mfma_f32_16x16x32_bf16 v[132:135], v[100:103], v[64:67], v[132:135]
    s_add_u32 s48, s48, 1
    s_cmp_lt_u32 s48, 10
    v_mfma_f32_16x16x32_bf16 v[164:167], v[100:103], v[68:71], v[164:167]
    v_mfma_f32_16x16x32_bf16 v[196:199], v[100:103], v[72:75], v[196:199]
    v_mfma_f32_16x16x32_bf16 v[228:231], v[100:103], v[76:79], v[228:231]
    v_mfma_f32_16x16x32_bf16 v[136:139], v[104:107], v[64:67], v[136:139]
    v_mfma_f32_16x16x32_bf16 v[168:171], v[104:107], v[68:71], v[168:171]
    v_mfma_f32_16x16x32_bf16 v[200:203], v[104:107], v[72:75], v[200:203]
    v_mfma_f32_16x16x32_bf16 v[232:235], v[104:107], v[76:79], v[232:235]
    v_mfma_f32_16x16x32_bf16 v[140:143], v[108:111], v[64:67], v[140:143]
    v_mfma_f32_16x16x32_bf16 v[172:175], v[108:111], v[68:71], v[172:175]
    v_mfma_f32_16x16x32_bf16 v[204:207], v[108:111], v[72:75], v[204:207]
    v_mfma_f32_16x16x32_bf16 v[236:239], v[108:111], v[76:79], v[236:239]
    s_waitcnt lgkmcnt(0)
    s_cbranch_scc1 L_ffn_loop
    v_cvt_pk_bf16_f32 v16, v112, v113
    v_cvt_pk_bf16_f32 v17, v114, v115
    v_cvt_pk_bf16_f32 v18, v116, v117
    v_cvt_pk_bf16_f32 v19, v118, v119
    v_pk_max_i16 v16, v16, 0
    v_pk_max_i16 v17, v17, 0
    v_pk_max_i16 v18, v18, 0
    v_pk_max_i16 v19, v19, 0
    s_nop 0
    s_add_u32 s59, s58, 0
    buffer_store_dwordx4 v[16:19], v9, s[28:31], s59 offen offset:0 sc1
    v_cvt_pk_bf16_f32 v20, v144, v145
    v_cvt_pk_bf16_f32 v21, v146, v147
    v_cvt_pk_bf16_f32 v22, v148, v149
    v_cvt_pk_bf16_f32 v23, v150, v151
    v_pk_max_i16 v20, v20, 0
    v_pk_max_i16 v21, v21, 0
    v_pk_max_i16 v22, v22, 0
    v_pk_max_i16 v23, v23, 0
    s_nop 0
    s_add_u32 s59, s58, 0
    buffer_store_dwordx4 v[20:23], v9, s[28:31], s59 offen offset:2048 sc1
    v_cvt_pk_bf16_f32 v24, v176, v177
    v_cvt_pk_bf16_f32 v25, v178, v179
    v_cvt_pk_bf16_f32 v26, v180, v181
    v_cvt_pk_bf16_f32 v27, v182, v183
    v_pk_max_i16 v24, v24, 0
    v_pk_max_i16 v25, v25, 0
    v_pk_max_i16 v26, v26, 0
    v_pk_max_i16 v27, v27, 0
    s_add_u32 s59, s58, 278528
    buffer_store_dwordx4 v[24:27], v9, s[28:31], s59 offen offset:0 sc1
    v_cvt_pk_bf16_f32 v28, v208, v209
    v_cvt_pk_bf16_f32 v29, v210, v211
    v_cvt_pk_bf16_f32 v30, v212, v213
    v_cvt_pk_bf16_f32 v31, v214, v215
    v_pk_max_i16 v28, v28, 0
    v_pk_max_i16 v29, v29, 0
    v_pk_max_i16 v30, v30, 0
    v_pk_max_i16 v31, v31, 0
    s_add_u32 s59, s58, 278528
    buffer_store_dwordx4 v[28:31], v9, s[28:31], s59 offen offset:2048 sc1
    v_cvt_pk_bf16_f32 v32, v120, v121
    v_cvt_pk_bf16_f32 v33, v122, v123
    v_cvt_pk_bf16_f32 v34, v124, v125
    v_cvt_pk_bf16_f32 v35, v126, v127
    v_pk_max_i16 v32, v32, 0
    v_pk_max_i16 v33, v33, 0
    v_pk_max_i16 v34, v34, 0
    v_pk_max_i16 v35, v35, 0
    s_add_u32 s59, s58, 4096
    buffer_store_dwordx4 v[32:35], v9, s[28:31], s59 offen offset:0 sc1
    v_cvt_pk_bf16_f32 v36, v152, v153
    v_cvt_pk_bf16_f32 v37, v154, v155
    v_cvt_pk_bf16_f32 v38, v156, v157
    v_cvt_pk_bf16_f32 v39, v158, v159
    v_pk_max_i16 v36, v36, 0
    v_pk_max_i16 v37, v37, 0
    v_pk_max_i16 v38, v38, 0
    v_pk_max_i16 v39, v39, 0
    s_add_u32 s59, s58, 4096
    buffer_store_dwordx4 v[36:39], v9, s[28:31], s59 offen offset:2048 sc1
    v_cvt_pk_bf16_f32 v40, v184, v185
    v_cvt_pk_bf16_f32 v41, v186, v187
    v_cvt_pk_bf16_f32 v42, v188, v189
    v_cvt_pk_bf16_f32 v43, v190, v191
    v_pk_max_i16 v40, v40, 0
    v_pk_max_i16 v41, v41, 0
    v_pk_max_i16 v42, v42, 0
    v_pk_max_i16 v43, v43, 0
    s_add_u32 s59, s58, 282624
    buffer_store_dwordx4 v[40:43], v9, s[28:31], s59 offen offset:0 sc1
    v_cvt_pk_bf16_f32 v44, v216, v217
    v_cvt_pk_bf16_f32 v45, v218, v219
    v_cvt_pk_bf16_f32 v46, v220, v221
    v_cvt_pk_bf16_f32 v47, v222, v223
    v_pk_max_i16 v44, v44, 0
    v_pk_max_i16 v45, v45, 0
    v_pk_max_i16 v46, v46, 0
    v_pk_max_i16 v47, v47, 0
    s_add_u32 s59, s58, 282624
    buffer_store_dwordx4 v[44:47], v9, s[28:31], s59 offen offset:2048 sc1
    v_cvt_pk_bf16_f32 v48, v128, v129
    v_cvt_pk_bf16_f32 v49, v130, v131
    v_cvt_pk_bf16_f32 v50, v132, v133
    v_cvt_pk_bf16_f32 v51, v134, v135
    v_pk_max_i16 v48, v48, 0
    v_pk_max_i16 v49, v49, 0
    v_pk_max_i16 v50, v50, 0
    v_pk_max_i16 v51, v51, 0
    s_add_u32 s59, s58, 8192
    buffer_store_dwordx4 v[48:51], v9, s[28:31], s59 offen offset:0 sc1
    v_cvt_pk_bf16_f32 v52, v160, v161
    v_cvt_pk_bf16_f32 v53, v162, v163
    v_cvt_pk_bf16_f32 v54, v164, v165
    v_cvt_pk_bf16_f32 v55, v166, v167
    v_pk_max_i16 v52, v52, 0
    v_pk_max_i16 v53, v53, 0
    v_pk_max_i16 v54, v54, 0
    v_pk_max_i16 v55, v55, 0
    s_add_u32 s59, s58, 8192
    buffer_store_dwordx4 v[52:55], v9, s[28:31], s59 offen offset:2048 sc1
    v_cvt_pk_bf16_f32 v56, v192, v193
    v_cvt_pk_bf16_f32 v57, v194, v195
    v_cvt_pk_bf16_f32 v58, v196, v197
    v_cvt_pk_bf16_f32 v59, v198, v199
    v_pk_max_i16 v56, v56, 0
    v_pk_max_i16 v57, v57, 0
    v_pk_max_i16 v58, v58, 0
    v_pk_max_i16 v59, v59, 0
    s_add_u32 s59, s58, 286720
    buffer_store_dwordx4 v[56:59], v9, s[28:31], s59 offen offset:0 sc1
    v_cvt_pk_bf16_f32 v60, v224, v225
    v_cvt_pk_bf16_f32 v61, v226, v227
    v_cvt_pk_bf16_f32 v62, v228, v229
    v_cvt_pk_bf16_f32 v63, v230, v231
    v_pk_max_i16 v60, v60, 0
    v_pk_max_i16 v61, v61, 0
    v_pk_max_i16 v62, v62, 0
    v_pk_max_i16 v63, v63, 0
    s_add_u32 s59, s58, 286720
    buffer_store_dwordx4 v[60:63], v9, s[28:31], s59 offen offset:2048 sc1
    v_cvt_pk_bf16_f32 v64, v136, v137
    v_cvt_pk_bf16_f32 v65, v138, v139
    v_cvt_pk_bf16_f32 v66, v140, v141
    v_cvt_pk_bf16_f32 v67, v142, v143
    v_pk_max_i16 v64, v64, 0
    v_pk_max_i16 v65, v65, 0
    v_pk_max_i16 v66, v66, 0
    v_pk_max_i16 v67, v67, 0
    s_add_u32 s59, s58, 12288
    buffer_store_dwordx4 v[64:67], v9, s[28:31], s59 offen offset:0 sc1
    v_cvt_pk_bf16_f32 v68, v168, v169
    v_cvt_pk_bf16_f32 v69, v170, v171
    v_cvt_pk_bf16_f32 v70, v172, v173
    v_cvt_pk_bf16_f32 v71, v174, v175
    v_pk_max_i16 v68, v68, 0
    v_pk_max_i16 v69, v69, 0
    v_pk_max_i16 v70, v70, 0
    v_pk_max_i16 v71, v71, 0
    s_add_u32 s59, s58, 12288
    buffer_store_dwordx4 v[68:71], v9, s[28:31], s59 offen offset:2048 sc1
    v_cvt_pk_bf16_f32 v72, v200, v201
    v_cvt_pk_bf16_f32 v73, v202, v203
    v_cvt_pk_bf16_f32 v74, v204, v205
    v_cvt_pk_bf16_f32 v75, v206, v207
    v_pk_max_i16 v72, v72, 0
    v_pk_max_i16 v73, v73, 0
    v_pk_max_i16 v74, v74, 0
    v_pk_max_i16 v75, v75, 0
    s_add_u32 s59, s58, 290816
    buffer_store_dwordx4 v[72:75], v9, s[28:31], s59 offen offset:0 sc1
    v_cvt_pk_bf16_f32 v76, v232, v233
    v_cvt_pk_bf16_f32 v77, v234, v235
    v_cvt_pk_bf16_f32 v78, v236, v237
    v_cvt_pk_bf16_f32 v79, v238, v239
    v_pk_max_i16 v76, v76, 0
    v_pk_max_i16 v77, v77, 0
    v_pk_max_i16 v78, v78, 0
    v_pk_max_i16 v79, v79, 0
    s_add_u32 s59, s58, 290816
    buffer_store_dwordx4 v[76:79], v9, s[28:31], s59 offen offset:2048 sc1
    s_endpgm
    s_nop 0
L1_prep:
    s_sub_u32 s37, s34, 30
    s_lshl_b32 s37, s37, 3
    s_add_u32 s37, s37, s33
    s_waitcnt lgkmcnt(0)
    s_mov_b32 s24, s8
    s_mov_b32 s25, s9
    s_mov_b32 s26, 819200
    s_mov_b32 s27, 0x00020000
    s_mov_b32 s40, s14
    s_mov_b32 s41, s15
    s_mov_b32 s42, 1966080
    s_mov_b32 s43, 0x00020000
    s_mov_b32 s28, s16
    s_mov_b32 s29, s17
    s_mov_b32 s30, 12591104
    s_mov_b32 s31, 0x00020000
    s_cmp_lt_u32 s3, 4
    s_cbranch_scc0 L1_prep_not
    s_mov_b32 s20, s4
    s_mov_b32 s21, s5
    s_mov_b32 s22, 2621440
    s_mov_b32 s23, 0x00020000
    s_mov_b32 s56, s6
    s_mov_b32 s57, s7
    s_mov_b32 s58, 2457600
    s_mov_b32 s59, 0x00020000
    s_mov_b32 s60, s12
    s_mov_b32 s61, s13
    s_mov_b32 s62, 1966080
    s_mov_b32 s63, 0x00020000
    s_nop 0
    s_lshl_b32 s64, s33, 7
    s_lshl_b32 s65, s34, 2
    s_add_u32 s64, s64, s65
    s_add_u32 s64, s64, s3
    s_lshl_b32 s65, s64, 10
    v_lshl_add_u32 v124, v0, 4, s65
    v_add_u32 v125, 2342912, v124
    v_add_u32 v126, 1245184, v124
    s_mul_i32 s65, s64, 2560
    v_lshrrev_b32_e64 v127, 5, v0
    v_mul_u32_u24 v127, 0x500, v127
    v_and_b32_e64 v128, 31, v0
    v_lshl_add_u32 v127, v128, 4, v127
    v_lshrrev_b32_e64 v128, 3, v0
    v_mul_u32_u24 v128, 0x500, v128
    v_and_b32_e64 v129, 7, v0
    v_lshl_add_u32 v128, v129, 4, v128
    v_mov_b32 v129, 0x40000000
    v_cmp_gt_u32 vcc, 16, v0
    s_nop 1
    v_cndmask_b32 v128, v129, v128, vcc
    s_mov_b32 s66, 245760
    s_mov_b32 s67, 196608
    s_mov_b32 s68, 1294336
    buffer_load_dwordx4 v[132:135], v127, s[20:23], s65 offen offset:128
    buffer_load_dwordx4 v[136:139], v124, s[56:59], s66 offen offset:0
    buffer_load_dwordx4 v[140:143], v124, s[60:63], s67 offen offset:0
    buffer_load_dwordx4 v[144:147], v127, s[20:23], s65 offen offset:640
    buffer_load_dwordx4 v[148:151], v124, s[56:59], s68 offen offset:0
    buffer_load_dwordx4 v[152:155], v126, s[60:63], 0 offen offset:0
    buffer_load_dwordx4 v[156:159], v128, s[20:23], s65 offen offset:1152
    buffer_load_dwordx4 v[160:163], v125, s[56:59], 0 offen offset:0
L1_prep_not:
    v_lshlrev_b32_e64 v7, 4, v0
    v_add_u32 v8, 4096, v7
    s_lshr_b32 s48, s3, 1
    s_and_b32 s49, s3, 1
    s_lshl_b32 s50, s48, 2
    s_lshl_b32 s51, s49, 4
    s_add_u32 s51, s51, s50
    s_mul_i32 s55, s37, 96
    s_add_u32 s55, s55, s51
    s_mul_i32 s55, s55, 1280
    buffer_load_dwordx4 v[24:27], v7, s[40:43], s55 offen offset:0
    buffer_load_dwordx4 v[28:31], v7, s[40:43], s55 offen offset:1024
    buffer_load_dwordx4 v[32:35], v7, s[40:43], s55 offen offset:2048
    buffer_load_dwordx4 v[36:39], v7, s[40:43], s55 offen offset:3072
    buffer_load_dwordx4 v[40:43], v8, s[40:43], s55 offen offset:0
    s_add_u32 s55, s55, 40960
    buffer_load_dwordx4 v[44:47], v7, s[40:43], s55 offen offset:0
    buffer_load_dwordx4 v[48:51], v7, s[40:43], s55 offen offset:1024
    buffer_load_dwordx4 v[52:55], v7, s[40:43], s55 offen offset:2048
    buffer_load_dwordx4 v[56:59], v7, s[40:43], s55 offen offset:3072
    buffer_load_dwordx4 v[60:63], v8, s[40:43], s55 offen offset:0
    s_add_u32 s55, s55, 40960
    buffer_load_dwordx4 v[64:67], v7, s[40:43], s55 offen offset:0
    buffer_load_dwordx4 v[68:71], v7, s[40:43], s55 offen offset:1024
    buffer_load_dwordx4 v[72:75], v7, s[40:43], s55 offen offset:2048
    buffer_load_dwordx4 v[76:79], v7, s[40:43], s55 offen offset:3072
    buffer_load_dwordx4 v[80:83], v8, s[40:43], s55 offen offset:0
    s_mul_i32 s51, s49, 20
    s_mul_i32 s55, s37, 40
    s_add_u32 s55, s55, s50
    s_add_u32 s55, s55, s51
    s_mul_i32 s55, s55, 1280
    buffer_load_dwordx4 v[84:87], v7, s[24:27], s55 offen offset:0
    buffer_load_dwordx4 v[88:91], v7, s[24:27], s55 offen offset:1024
    buffer_load_dwordx4 v[92:95], v7, s[24:27], s55 offen offset:2048
    buffer_load_dwordx4 v[96:99], v7, s[24:27], s55 offen offset:3072
    buffer_load_dwordx4 v[100:103], v8, s[24:27], s55 offen offset:0
    s_and_b32 s56, s37, 3
    s_lshr_b32 s61, s37, 2
    s_mul_i32 s55, s56, 160
    s_mul_i32 s50, s48, 40
    s_add_u32 s55, s55, s50
    s_add_u32 s55, s55, s51
    s_add_u32 s55, s55, 16
    s_mul_i32 s55, s55, 1280
    s_mul_i32 s50, s61, 320
    s_add_u32 s55, s55, s50
    s_movk_i32 s52, 1456
    s_mul_i32 s53, s3, 5824
    s_add_u32 s54, s53, s50
    s_movk_i32 s57, 1280
    v_mul_u32_u24 v2, 13, v0
    v_lshrrev_b32 v2, 8, v2
    v_mul_u32_u24 v3, 20, v2
    v_sub_u32 v1, v0, v3
    v_lshlrev_b32_e64 v1, 4, v1
    v_mad_u32_u24 v9, v2, s57, v1
    v_mad_u32_u24 v11, v2, s52, v1
    v_add_u32_e64 v11, s54, v11
    v_add_u32 v10, 3904, v7
    v_mov_b32 v3, 0x40000000
    v_cmp_gt_u32 vcc, 16, v0
    s_nop 1
    v_cndmask_b32 v10, v3, v10, vcc
    buffer_load_dwordx4 v[104:107], v9, s[24:27], s55 offen
    buffer_load_dwordx4 v[108:111], v10, s[24:27], s55 offen
    s_add_u32 s54, s54, 4432
    v_add_u32 v12, s54, v7
    s_movk_i32 s50, 205
    v_add_u32 v1, 0, v0
    v_mul_u32_u24 v2, s50, v1
    v_lshrrev_b32_e64 v2, 14, v2
    v_mul_u32_u24 v2, 176, v2
    v_lshl_add_u32 v1, v1, 4, v2
    v_add_u32 v19, s53, v1
    v_add_u32 v1, 64, v0
    v_mul_u32_u24 v2, s50, v1
    v_lshrrev_b32 v2, 14, v2
    v_mul_u32_u24 v2, 176, v2
    v_lshl_add_u32 v1, v1, 4, v2
    v_add_u32_e64 v20, s53, v1
    v_add_u32 v1, 128, v0
    v_mul_u32_u24 v2, s50, v1
    v_lshrrev_b32 v2, 14, v2
    v_mul_u32_u24 v2, 176, v2
    v_lshl_add_u32 v1, v1, 4, v2
    v_add_u32_e64 v21, s53, v1
    v_add_u32 v1, 192, v0
    v_mul_u32_u24 v2, s50, v1
    v_lshrrev_b32 v2, 14, v2
    v_mul_u32_u24 v2, 176, v2
    v_lshl_add_u32 v1, v1, 4, v2
    v_add_u32_e64 v22, s53, v1
    v_add_u32 v1, 256, v0
    v_mul_u32_u24 v2, s50, v1
    v_lshrrev_b32 v2, 14, v2
    v_mul_u32_u24 v2, 176, v2
    v_lshl_add_u32 v1, v1, 4, v2
    v_add_u32_e64 v23, s53, v1
    s_mul_i32 s49, s3, 160
    v_lshrrev_b32_e64 v4, 4, v0
    v_bfe_u32 v5, v0, 2, 2
    v_lshl_add_u32 v4, v4, 3, v5
    v_mul_u32_u24 v4, s52, v4
    v_add_u32 v4, s49, v4
    v_and_b32_e64 v5, 3, v0
    v_lshl_add_u32 v6, v5, 3, v4
    v_lshl_add_u32 v5, v5, 4, v4
    s_mul_i32 s59, s3, 348160
    s_add_u32 s59, s59, 9437184
    s_nop 0
    s_waitcnt vmcnt(17)
    ds_write_b128 v19, v[24:27] offset:0
    ds_write_b128 v20, v[28:31] offset:0
    ds_write_b128 v21, v[32:35] offset:0
    ds_write_b128 v22, v[36:39] offset:0
    ds_write_b128 v23, v[40:43] offset:0
    s_mul_i32 s60, s37, 3
    s_add_u32 s60, s60, 20
    s_mul_i32 s60, s60, 5120
    s_nop 0
    s_add_u32 s60, s60, s59
    s_waitcnt lgkmcnt(0)
    s_barrier
    ds_read_b64_tr_b16 v[24:25], v5 offset:0
    ds_read_b64_tr_b16 v[26:27], v5 offset:5824
    ds_read_b64_tr_b16 v[28:29], v5 offset:8
    ds_read_b64_tr_b16 v[30:31], v5 offset:5832
    ds_read_b64_tr_b16 v[32:33], v5 offset:64
    ds_read_b64_tr_b16 v[34:35], v5 offset:5888
    ds_read_b64_tr_b16 v[36:37], v5 offset:72
    ds_read_b64_tr_b16 v[38:39], v5 offset:5896
    ds_read_b64_tr_b16 v[40:41], v6 offset:128
    ds_read_b64_tr_b16 v[42:43], v6 offset:5952
    s_nop 0
    s_waitcnt lgkmcnt(0)
    buffer_store_dwordx4 v[24:27], v7, s[28:31], s60 offen offset:0 sc1
    buffer_store_dwordx4 v[28:31], v7, s[28:31], s60 offen offset:1024 sc1
    buffer_store_dwordx4 v[32:35], v7, s[28:31], s60 offen offset:2048 sc1
    buffer_store_dwordx4 v[36:39], v7, s[28:31], s60 offen offset:3072 sc1
    buffer_store_dwordx4 v[40:43], v8, s[28:31], s60 offen offset:0 sc1
    s_nop 0
    s_waitcnt vmcnt(17)
    ds_write_b128 v19, v[44:47] offset:46592
    ds_write_b128 v20, v[48:51] offset:46592
    ds_write_b128 v21, v[52:55] offset:46592
    ds_write_b128 v22, v[56:59] offset:46592
    ds_write_b128 v23, v[60:63] offset:46592
    s_mul_i32 s60, s37, 3
    s_add_u32 s60, s60, 21
    s_mul_i32 s60, s60, 5120
    s_nop 0
    s_add_u32 s60, s60, s59
    s_waitcnt lgkmcnt(0)
    s_barrier
    ds_read_b64_tr_b16 v[44:45], v5 offset:46592
    ds_read_b64_tr_b16 v[46:47], v5 offset:52416
    ds_read_b64_tr_b16 v[48:49], v5 offset:46600
    ds_read_b64_tr_b16 v[50:51], v5 offset:52424
    ds_read_b64_tr_b16 v[52:53], v5 offset:46656
    ds_read_b64_tr_b16 v[54:55], v5 offset:52480
    ds_read_b64_tr_b16 v[56:57], v5 offset:46664
    ds_read_b64_tr_b16 v[58:59], v5 offset:52488
    ds_read_b64_tr_b16 v[60:61], v6 offset:46720
    ds_read_b64_tr_b16 v[62:63], v6 offset:52544
    s_nop 0
    s_waitcnt lgkmcnt(0)
    buffer_store_dwordx4 v[44:47], v7, s[28:31], s60 offen offset:0 sc1
    buffer_store_dwordx4 v[48:51], v7, s[28:31], s60 offen offset:1024 sc1
    buffer_store_dwordx4 v[52:55], v7, s[28:31], s60 offen offset:2048 sc1
    buffer_store_dwordx4 v[56:59], v7, s[28:31], s60 offen offset:3072 sc1
    buffer_store_dwordx4 v[60:63], v8, s[28:31], s60 offen offset:0 sc1
    s_nop 0
    s_waitcnt vmcnt(17)
    ds_write_b128 v19, v[64:67] offset:0
    ds_write_b128 v20, v[68:71] offset:0
    ds_write_b128 v21, v[72:75] offset:0
    ds_write_b128 v22, v[76:79] offset:0
    ds_write_b128 v23, v[80:83] offset:0
    s_mul_i32 s60, s37, 3
    s_add_u32 s60, s60, 22
    s_mul_i32 s60, s60, 5120
    s_nop 0
    s_add_u32 s60, s60, s59
    s_waitcnt lgkmcnt(0)
    s_barrier
    ds_read_b64_tr_b16 v[64:65], v5 offset:0
    ds_read_b64_tr_b16 v[66:67], v5 offset:5824
    ds_read_b64_tr_b16 v[68:69], v5 offset:8
    ds_read_b64_tr_b16 v[70:71], v5 offset:5832
    ds_read_b64_tr_b16 v[72:73], v5 offset:64
    ds_read_b64_tr_b16 v[74:75], v5 offset:5888
    ds_read_b64_tr_b16 v[76:77], v5 offset:72
    ds_read_b64_tr_b16 v[78:79], v5 offset:5896
    ds_read_b64_tr_b16 v[80:81], v6 offset:128
    ds_read_b64_tr_b16 v[82:83], v6 offset:5952
    s_nop 0
    s_waitcnt lgkmcnt(0)
    buffer_store_dwordx4 v[64:67], v7, s[28:31], s60 offen offset:0 sc1
    buffer_store_dwordx4 v[68:71], v7, s[28:31], s60 offen offset:1024 sc1
    buffer_store_dwordx4 v[72:75], v7, s[28:31], s60 offen offset:2048 sc1
    buffer_store_dwordx4 v[76:79], v7, s[28:31], s60 offen offset:3072 sc1
    buffer_store_dwordx4 v[80:83], v8, s[28:31], s60 offen offset:0 sc1
    s_nop 0
    s_waitcnt vmcnt(17)
    ds_write_b128 v19, v[84:87] offset:46592
    ds_write_b128 v20, v[88:91] offset:46592
    ds_write_b128 v21, v[92:95] offset:46592
    ds_write_b128 v22, v[96:99] offset:46592
    ds_write_b128 v23, v[100:103] offset:46592
    s_mov_b32 s60, s37
    s_mul_i32 s60, s60, 5120
    s_add_u32 s60, s60, s59
    s_waitcnt lgkmcnt(0)
    s_barrier
    ds_read_b64_tr_b16 v[84:85], v5 offset:46592
    ds_read_b64_tr_b16 v[86:87], v5 offset:52416
    ds_read_b64_tr_b16 v[88:89], v5 offset:46600
    ds_read_b64_tr_b16 v[90:91], v5 offset:52424
    ds_read_b64_tr_b16 v[92:93], v5 offset:46656
    ds_read_b64_tr_b16 v[94:95], v5 offset:52480
    ds_read_b64_tr_b16 v[96:97], v5 offset:46664
    ds_read_b64_tr_b16 v[98:99], v5 offset:52488
    ds_read_b64_tr_b16 v[100:101], v6 offset:46720
    ds_read_b64_tr_b16 v[102:103], v6 offset:52544
    s_nop 0
    s_waitcnt lgkmcnt(0)
    buffer_store_dwordx4 v[84:87], v7, s[28:31], s60 offen offset:0 sc1
    buffer_store_dwordx4 v[88:91], v7, s[28:31], s60 offen offset:1024 sc1
    buffer_store_dwordx4 v[92:95], v7, s[28:31], s60 offen offset:2048 sc1
    buffer_store_dwordx4 v[96:99], v7, s[28:31], s60 offen offset:3072 sc1
    buffer_store_dwordx4 v[100:103], v8, s[28:31], s60 offen offset:0 sc1
    s_nop 0
    s_waitcnt vmcnt(20)
    ds_write_b128 v11, v[104:107] offset:0
    s_mov_b64 exec, 0xffff
    ds_write_b128 v12, v[108:111] offset:0
    s_mov_b64 exec, -1
    s_add_u32 s60, s56, 16
    s_mul_i32 s60, s60, 5120
    s_nop 0
    s_add_u32 s60, s60, s59
    s_waitcnt lgkmcnt(0)
    s_barrier
    s_cmp_lg_u32 s61, s48
    s_cbranch_scc1 L1_prep_done
    ds_read_b64_tr_b16 v[104:105], v5 offset:0
    ds_read_b64_tr_b16 v[106:107], v5 offset:5824
    ds_read_b64_tr_b16 v[108:109], v5 offset:8
    ds_read_b64_tr_b16 v[110:111], v5 offset:5832
    ds_read_b64_tr_b16 v[112:113], v5 offset:64
    ds_read_b64_tr_b16 v[114:115], v5 offset:5888
    ds_read_b64_tr_b16 v[116:117], v5 offset:72
    ds_read_b64_tr_b16 v[118:119], v5 offset:5896
    ds_read_b64_tr_b16 v[120:121], v6 offset:128
    ds_read_b64_tr_b16 v[122:123], v6 offset:5952
    s_nop 0
    s_waitcnt lgkmcnt(0)
    buffer_store_dwordx4 v[104:107], v7, s[28:31], s60 offen offset:0 sc1
    buffer_store_dwordx4 v[108:111], v7, s[28:31], s60 offen offset:1024 sc1
    buffer_store_dwordx4 v[112:115], v7, s[28:31], s60 offen offset:2048 sc1
    buffer_store_dwordx4 v[116:119], v7, s[28:31], s60 offen offset:3072 sc1
    buffer_store_dwordx4 v[120:123], v8, s[28:31], s60 offen offset:0 sc1
L1_prep_done:
    s_endpgm
L1_end:
    s_endpgm
.globl gm_stage2_kernel
.p2align 8
.type gm_stage2_kernel,@function
gm_stage2_kernel:
    s_cmp_ge_u32 s2, 256
    s_cbranch_scc1 L2_end
    s_load_dwordx2 s[4:5], s[0:1], 72
    s_load_dwordx2 s[6:7], s[0:1], 56
    v_lshrrev_b32 v1, 6, v0
    v_and_b32 v0, 63, v0
    v_readfirstlane_b32 s3, v1
    s_and_b32 s16, s2, 7
    s_lshr_b32 s17, s2, 3
    s_and_b32 s18, s16, 1
    s_lshl_b32 s18, s18, 2
    s_and_b32 s19, s17, 3
    s_add_u32 s18, s18, s19
    s_lshr_b32 s19, s16, 1
    s_lshl_b32 s19, s19, 3
    s_lshr_b32 s20, s17, 2
    s_add_u32 s19, s19, s20
    s_lshl_b32 s20, s3, 4
    s_add_u32 s20, s20, 4
    s_cmp_eq_u32 s3, 0
    s_cselect_b32 s20, 0, s20
    s_lshl_b32 s20, s3, 4
    s_mov_b32 s21, 7
    s_mul_i32 s22, s19, 278528
    s_lshl_b32 s23, s20, 12
    s_add_u32 s22, s22, s23
    s_mul_i32 s23, s18, 348160
    s_mul_i32 s24, s20, 5120
    s_add_u32 s23, s23, s24
    s_add_u32 s23, s23, 9437184
    v_lshlrev_b32 v2, 4, v0
    v_add_u32 v3, 4096, v2
    s_add_u32 s24, s3, 0
    s_and_b32 s24, s24, 3
    s_lshl_b32 s25, s24, 10
    v_add_u32 v4, s25, v2
    s_add_u32 s24, s3, 1
    s_and_b32 s24, s24, 3
    s_lshl_b32 s25, s24, 10
    v_add_u32 v5, s25, v2
    s_mul_i32 s25, s24, 15360
    s_add_u32 s25, s25, 0
    v_add_u32 v9, s25, v2
    s_add_u32 s24, s3, 2
    s_and_b32 s24, s24, 3
    s_lshl_b32 s25, s24, 10
    v_add_u32 v6, s25, v2
    s_mul_i32 s25, s24, 15360
    s_add_u32 s25, s25, 5120
    v_add_u32 v10, s25, v2
    s_add_u32 s24, s3, 3
    s_and_b32 s24, s24, 3
    s_lshl_b32 s25, s24, 10
    v_add_u32_e64 v7, s25, v2
    s_mul_i32 s25, s24, 15360
    s_add_u32 s25, s25, 10240
    v_add_u32 v11, s25, v2
    s_lshl_b32 s24, s19, 6
    s_lshr_b32 s25, s3, 1
    s_lshl_b32 s25, s25, 5
    s_add_u32 s24, s24, s25
    s_and_b32 s25, s3, 1
    s_add_u32 s24, s24, s25
    v_and_b32 v12, 15, v0
    v_lshl_add_u32 v12, v12, 1, s24
    v_lshlrev_b32_e64 v13, 2, v12
    s_mov_b32 s26, 12582912
    s_movk_i32 s27, 4096
    s_waitcnt lgkmcnt(0)
    s_mov_b32 s8, s4
    s_mov_b32 s9, s5
    s_mov_b32 s10, 12591104
    s_mov_b32 s11, 0x00020000
    buffer_load_dword v14, v13, s[8:11], s26 offen
    buffer_load_dwordx4 v[16:19], v2, s[8:11], s23 offen offset:0
    buffer_load_dwordx4 v[20:23], v2, s[8:11], s23 offen offset:1024
    buffer_load_dwordx4 v[24:27], v2, s[8:11], s23 offen offset:2048
    buffer_load_dwordx4 v[28:31], v2, s[8:11], s23 offen offset:3072
    buffer_load_dwordx4 v[32:35], v3, s[8:11], s23 offen offset:0
    buffer_load_dwordx4 v[36:39], v4, s[8:11], s22 offen
    buffer_load_dwordx4 v[40:43], v5, s[8:11], s22 offen
    buffer_load_dwordx4 v[44:47], v6, s[8:11], s22 offen
    buffer_load_dwordx4 v[48:51], v7, s[8:11], s22 offen
    s_add_u32 s23, s23, 5120
    s_nop 0
    s_add_u32 s22, s22, s27
    buffer_load_dwordx4 v[52:55], v2, s[8:11], s23 offen offset:0
    buffer_load_dwordx4 v[56:59], v2, s[8:11], s23 offen offset:1024
    buffer_load_dwordx4 v[60:63], v2, s[8:11], s23 offen offset:2048
    buffer_load_dwordx4 v[64:67], v2, s[8:11], s23 offen offset:3072
    buffer_load_dwordx4 v[68:71], v3, s[8:11], s23 offen offset:0
    buffer_load_dwordx4 v[72:75], v4, s[8:11], s22 offen
    buffer_load_dwordx4 v[76:79], v5, s[8:11], s22 offen
    buffer_load_dwordx4 v[80:83], v6, s[8:11], s22 offen
    buffer_load_dwordx4 v[84:87], v7, s[8:11], s22 offen
    s_add_u32 s23, s23, 5120
    s_nop 0
    s_add_u32 s22, s22, s27
    s_mov_b32 s12, s6
    s_mov_b32 s13, s7
    s_mov_b32 s14, 2621440
    s_mov_b32 s15, 0x00020000
    v_mov_b64 v[160:161], 0
    v_mov_b64 v[162:163], 0
    v_mov_b64 v[164:165], 0
    v_mov_b64 v[166:167], 0
    v_mov_b64 v[168:169], 0
    v_mov_b64 v[170:171], 0
    v_mov_b64 v[172:173], 0
    v_mov_b64 v[174:175], 0
    v_mov_b64 v[176:177], 0
    v_mov_b64 v[178:179], 0
    v_mov_b64 v[180:181], 0
    v_mov_b64 v[182:183], 0
    v_mov_b64 v[184:185], 0
    v_mov_b64 v[186:187], 0
    v_mov_b64 v[188:189], 0
    v_mov_b64 v[190:191], 0
    v_mov_b64 v[192:193], 0
    v_mov_b64 v[194:195], 0
    v_mov_b64 v[196:197], 0
    v_mov_b64 v[198:199], 0
    v_mov_b64 v[200:201], 0
    v_mov_b64 v[202:203], 0
    v_mov_b64 v[204:205], 0
    v_mov_b64 v[206:207], 0
    v_mov_b64 v[208:209], 0
    v_mov_b64 v[210:211], 0
    v_mov_b64 v[212:213], 0
    v_mov_b64 v[214:215], 0
    v_mov_b64 v[216:217], 0
    v_mov_b64 v[218:219], 0
    v_mov_b64 v[220:221], 0
    v_mov_b64 v[222:223], 0
    v_mov_b64 v[224:225], 0
    v_mov_b64 v[226:227], 0
    v_mov_b64 v[228:229], 0
    v_mov_b64 v[230:231], 0
    v_mov_b64 v[232:233], 0
    v_mov_b64 v[234:235], 0
    v_mov_b64 v[236:237], 0
    v_mov_b64 v[238:239], 0
    s_mul_i32 s25, s3, 15360
    v_add_u32_e64 v8, s25, v2
    s_mul_i32 s25, s3, 5120
    s_add_u32 s29, s25, 81920
    s_mul_i32 s31, s18, 348160
    s_nop 0
    s_add_u32 s31, s31, s25
    s_add_u32 s31, s31, 9764864
    s_mul_i32 s30, s19, 278528
    s_add_u32 s30, s30, 262144
    s_add_u32 s25, s25, 0xf000
    v_add_u32_e64 v15, s25, v2
    s_mul_i32 s25, s18, 160
    v_mul_u32_u24 v12, 0x500, v12
    v_lshrrev_b32_e64 v1, 4, v0
    v_lshl_add_u32 v0, v1, 3, v12
    v_lshl_add_u32 v12, v1, 4, v12
    v_add_u32 v1, 0xf000, v2
    s_nop 0
    s_cmp_eq_u32 s3, 1
    s_cselect_b32 s28, 6, 0
L2_loop:
    s_waitcnt vmcnt(9)
    v_mfma_f32_16x16x32_bf16 v[160:163], v[16:19], v[36:39], v[160:163]
    v_mfma_f32_16x16x32_bf16 v[180:183], v[16:19], v[40:43], v[180:183]
    v_mfma_f32_16x16x32_bf16 v[200:203], v[16:19], v[44:47], v[200:203]
    v_mfma_f32_16x16x32_bf16 v[220:223], v[16:19], v[48:51], v[220:223]
    buffer_load_dwordx4 v[16:19], v2, s[8:11], s23 offen offset:0
    v_mfma_f32_16x16x32_bf16 v[164:167], v[20:23], v[36:39], v[164:167]
    v_mfma_f32_16x16x32_bf16 v[184:187], v[20:23], v[40:43], v[184:187]
    v_mfma_f32_16x16x32_bf16 v[204:207], v[20:23], v[44:47], v[204:207]
    v_mfma_f32_16x16x32_bf16 v[224:227], v[20:23], v[48:51], v[224:227]
    buffer_load_dwordx4 v[20:23], v2, s[8:11], s23 offen offset:1024
    v_mfma_f32_16x16x32_bf16 v[168:171], v[24:27], v[36:39], v[168:171]
    v_mfma_f32_16x16x32_bf16 v[188:191], v[24:27], v[40:43], v[188:191]
    v_mfma_f32_16x16x32_bf16 v[208:211], v[24:27], v[44:47], v[208:211]
    v_mfma_f32_16x16x32_bf16 v[228:231], v[24:27], v[48:51], v[228:231]
    buffer_load_dwordx4 v[24:27], v2, s[8:11], s23 offen offset:2048
    v_mfma_f32_16x16x32_bf16 v[172:175], v[28:31], v[36:39], v[172:175]
    v_mfma_f32_16x16x32_bf16 v[192:195], v[28:31], v[40:43], v[192:195]
    v_mfma_f32_16x16x32_bf16 v[212:215], v[28:31], v[44:47], v[212:215]
    v_mfma_f32_16x16x32_bf16 v[232:235], v[28:31], v[48:51], v[232:235]
    buffer_load_dwordx4 v[28:31], v2, s[8:11], s23 offen offset:3072
    v_mfma_f32_16x16x32_bf16 v[176:179], v[32:35], v[36:39], v[176:179]
    v_mfma_f32_16x16x32_bf16 v[196:199], v[32:35], v[40:43], v[196:199]
    v_mfma_f32_16x16x32_bf16 v[216:219], v[32:35], v[44:47], v[216:219]
    v_mfma_f32_16x16x32_bf16 v[236:239], v[32:35], v[48:51], v[236:239]
    buffer_load_dwordx4 v[32:35], v3, s[8:11], s23 offen offset:0
    buffer_load_dwordx4 v[36:39], v4, s[8:11], s22 offen
    buffer_load_dwordx4 v[40:43], v5, s[8:11], s22 offen
    buffer_load_dwordx4 v[44:47], v6, s[8:11], s22 offen
    buffer_load_dwordx4 v[48:51], v7, s[8:11], s22 offen
    s_add_u32 s23, s23, 5120
    s_add_u32 s22, s22, s27
    s_waitcnt vmcnt(9)
    v_mfma_f32_16x16x32_bf16 v[160:163], v[52:55], v[72:75], v[160:163]
    v_mfma_f32_16x16x32_bf16 v[180:183], v[52:55], v[76:79], v[180:183]
    v_mfma_f32_16x16x32_bf16 v[200:203], v[52:55], v[80:83], v[200:203]
    v_mfma_f32_16x16x32_bf16 v[220:223], v[52:55], v[84:87], v[220:223]
    buffer_load_dwordx4 v[52:55], v2, s[8:11], s23 offen offset:0
    v_mfma_f32_16x16x32_bf16 v[164:167], v[56:59], v[72:75], v[164:167]
    v_mfma_f32_16x16x32_bf16 v[184:187], v[56:59], v[76:79], v[184:187]
    v_mfma_f32_16x16x32_bf16 v[204:207], v[56:59], v[80:83], v[204:207]
    v_mfma_f32_16x16x32_bf16 v[224:227], v[56:59], v[84:87], v[224:227]
    buffer_load_dwordx4 v[56:59], v2, s[8:11], s23 offen offset:1024
    v_mfma_f32_16x16x32_bf16 v[168:171], v[60:63], v[72:75], v[168:171]
    v_mfma_f32_16x16x32_bf16 v[188:191], v[60:63], v[76:79], v[188:191]
    v_mfma_f32_16x16x32_bf16 v[208:211], v[60:63], v[80:83], v[208:211]
    v_mfma_f32_16x16x32_bf16 v[228:231], v[60:63], v[84:87], v[228:231]
    buffer_load_dwordx4 v[60:63], v2, s[8:11], s23 offen offset:2048
    v_mfma_f32_16x16x32_bf16 v[172:175], v[64:67], v[72:75], v[172:175]
    v_mfma_f32_16x16x32_bf16 v[192:195], v[64:67], v[76:79], v[192:195]
    v_mfma_f32_16x16x32_bf16 v[212:215], v[64:67], v[80:83], v[212:215]
    v_mfma_f32_16x16x32_bf16 v[232:235], v[64:67], v[84:87], v[232:235]
    buffer_load_dwordx4 v[64:67], v2, s[8:11], s23 offen offset:3072
    v_mfma_f32_16x16x32_bf16 v[176:179], v[68:71], v[72:75], v[176:179]
    v_mfma_f32_16x16x32_bf16 v[196:199], v[68:71], v[76:79], v[196:199]
    v_mfma_f32_16x16x32_bf16 v[216:219], v[68:71], v[80:83], v[216:219]
    v_mfma_f32_16x16x32_bf16 v[236:239], v[68:71], v[84:87], v[236:239]
    buffer_load_dwordx4 v[68:71], v3, s[8:11], s23 offen offset:0
    buffer_load_dwordx4 v[72:75], v4, s[8:11], s22 offen
    buffer_load_dwordx4 v[76:79], v5, s[8:11], s22 offen
    buffer_load_dwordx4 v[80:83], v6, s[8:11], s22 offen
    buffer_load_dwordx4 v[84:87], v7, s[8:11], s22 offen
    s_add_u32 s23, s23, 5120
    s_nop 0
    s_add_u32 s22, s22, s27
    s_cmp_eq_u32 s21, s28
    s_cbranch_scc1 L2_dump
L2_back:
    s_cmp_lg_u32 s21, 4
    s_cbranch_scc1 L2_nobar
    s_waitcnt lgkmcnt(0)
    s_barrier
    ds_read_b128 v[124:127], v15 offset:0
    ds_read_b128 v[128:131], v15 offset:1024
    ds_read_b128 v[132:135], v15 offset:2048
    ds_read_b128 v[136:139], v15 offset:3072
    ds_read_b128 v[140:143], v15 offset:4096
    v_sub_f32 v15, 1.0, v14
    s_cmp_eq_u32 s3, 0
    s_cselect_b64 vcc, -1, 0
    v_cndmask_b32 v144, v15, v14, vcc
    s_cmp_eq_u32 s3, 1
    s_cselect_b64 vcc, -1, 0
    v_cndmask_b32 v146, v15, v14, vcc
    s_cmp_eq_u32 s3, 2
    s_cselect_b64 vcc, -1, 0
    v_cndmask_b32 v148, v15, v14, vcc
    s_cmp_eq_u32 s3, 3
    s_cselect_b64 vcc, -1, 0
    v_cndmask_b32 v150, v15, v14, vcc
    s_waitcnt lgkmcnt(0)
    v_pk_mul_f32 v[124:125], v[124:125], v[14:15] op_sel_hi:[1,0]
    v_pk_mul_f32 v[126:127], v[126:127], v[14:15] op_sel_hi:[1,0]
    v_pk_mul_f32 v[128:129], v[128:129], v[14:15] op_sel_hi:[1,0]
    v_pk_mul_f32 v[130:131], v[130:131], v[14:15] op_sel_hi:[1,0]
    v_pk_mul_f32 v[132:133], v[132:133], v[14:15] op_sel_hi:[1,0]
    v_pk_mul_f32 v[134:135], v[134:135], v[14:15] op_sel_hi:[1,0]
    v_pk_mul_f32 v[136:137], v[136:137], v[14:15] op_sel_hi:[1,0]
    v_pk_mul_f32 v[138:139], v[138:139], v[14:15] op_sel_hi:[1,0]
    v_pk_mul_f32 v[140:141], v[140:141], v[14:15] op_sel_hi:[1,0]
    v_pk_mul_f32 v[142:143], v[142:143], v[14:15] op_sel_hi:[1,0]
L2_nobar:
    s_sub_u32 s21, s21, 1
    s_cmp_lg_u32 s21, 0
    s_cbranch_scc1 L2_loop
    s_mov_b32 m0, s29
    v_add_u32 v13, 81920, v2
    s_nop 0
    s_waitcnt vmcnt(9)
    v_mfma_f32_16x16x32_bf16 v[160:163], v[16:19], v[36:39], v[160:163]
    v_mfma_f32_16x16x32_bf16 v[180:183], v[16:19], v[40:43], v[180:183]
    v_mfma_f32_16x16x32_bf16 v[200:203], v[16:19], v[44:47], v[200:203]
    v_mfma_f32_16x16x32_bf16 v[220:223], v[16:19], v[48:51], v[220:223]
    buffer_load_dwordx4 v2, s[8:11], s31 offen offset:0 lds
    v_mfma_f32_16x16x32_bf16 v[164:167], v[20:23], v[36:39], v[164:167]
    v_mfma_f32_16x16x32_bf16 v[184:187], v[20:23], v[40:43], v[184:187]
    v_mfma_f32_16x16x32_bf16 v[204:207], v[20:23], v[44:47], v[204:207]
    v_mfma_f32_16x16x32_bf16 v[224:227], v[20:23], v[48:51], v[224:227]
    buffer_load_dwordx4 v2, s[8:11], s31 offen offset:1024 lds
    v_mfma_f32_16x16x32_bf16 v[168:171], v[24:27], v[36:39], v[168:171]
    v_mfma_f32_16x16x32_bf16 v[188:191], v[24:27], v[40:43], v[188:191]
    v_mfma_f32_16x16x32_bf16 v[208:211], v[24:27], v[44:47], v[208:211]
    v_mfma_f32_16x16x32_bf16 v[228:231], v[24:27], v[48:51], v[228:231]
    buffer_load_dwordx4 v2, s[8:11], s31 offen offset:2048 lds
    v_mfma_f32_16x16x32_bf16 v[172:175], v[28:31], v[36:39], v[172:175]
    v_mfma_f32_16x16x32_bf16 v[192:195], v[28:31], v[40:43], v[192:195]
    v_mfma_f32_16x16x32_bf16 v[212:215], v[28:31], v[44:47], v[212:215]
    v_mfma_f32_16x16x32_bf16 v[232:235], v[28:31], v[48:51], v[232:235]
    buffer_load_dwordx4 v2, s[8:11], s31 offen offset:3072 lds
    v_mfma_f32_16x16x32_bf16 v[176:179], v[32:35], v[36:39], v[176:179]
    s_nop 0
    s_add_u32 m0, m0, s27
    v_mfma_f32_16x16x32_bf16 v[196:199], v[32:35], v[40:43], v[196:199]
    v_mfma_f32_16x16x32_bf16 v[216:219], v[32:35], v[44:47], v[216:219]
    v_mfma_f32_16x16x32_bf16 v[236:239], v[32:35], v[48:51], v[236:239]
    buffer_load_dwordx4 v3, s[8:11], s31 offen offset:0 lds
    buffer_load_dwordx4 v[36:39], v4, s[8:11], s30 offen
    s_add_u32 s30, s30, s27
    buffer_load_dwordx4 v[40:43], v4, s[8:11], s30 offen
    s_add_u32 s30, s30, s27
    buffer_load_dwordx4 v[44:47], v4, s[8:11], s30 offen
    s_add_u32 s30, s30, s27
    buffer_load_dwordx4 v[48:51], v4, s[8:11], s30 offen
    s_waitcnt vmcnt(11)
    v_mfma_f32_16x16x32_bf16 v[180:183], v[52:55], v[76:79], v[180:183]
    v_mfma_f32_16x16x32_bf16 v[184:187], v[56:59], v[76:79], v[184:187]
    v_mfma_f32_16x16x32_bf16 v[188:191], v[60:63], v[76:79], v[188:191]
    v_mfma_f32_16x16x32_bf16 v[192:195], v[64:67], v[76:79], v[192:195]
    v_mfma_f32_16x16x32_bf16 v[196:199], v[68:71], v[76:79], v[196:199]
    s_waitcnt vmcnt(10)
    v_mfma_f32_16x16x32_bf16 v[200:203], v[52:55], v[80:83], v[200:203]
    s_nop 1
    ds_write_b128 v9, v[180:183] offset:0
    v_mfma_f32_16x16x32_bf16 v[204:207], v[56:59], v[80:83], v[204:207]
    ds_write_b128 v9, v[184:187] offset:1024
    v_mfma_f32_16x16x32_bf16 v[208:211], v[60:63], v[80:83], v[208:211]
    ds_write_b128 v9, v[188:191] offset:2048
    v_mfma_f32_16x16x32_bf16 v[212:215], v[64:67], v[80:83], v[212:215]
    ds_write_b128 v9, v[192:195] offset:3072
    v_mfma_f32_16x16x32_bf16 v[216:219], v[68:71], v[80:83], v[216:219]
    ds_write_b128 v9, v[196:199] offset:4096
    s_nop 0
    s_waitcnt vmcnt(9)
    v_mfma_f32_16x16x32_bf16 v[220:223], v[52:55], v[84:87], v[220:223]
    ds_write_b128 v10, v[200:203] offset:0
    v_mfma_f32_16x16x32_bf16 v[224:227], v[56:59], v[84:87], v[224:227]
    ds_write_b128 v10, v[204:207] offset:1024
    v_mfma_f32_16x16x32_bf16 v[228:231], v[60:63], v[84:87], v[228:231]
    ds_write_b128 v10, v[208:211] offset:2048
    v_mfma_f32_16x16x32_bf16 v[232:235], v[64:67], v[84:87], v[232:235]
    ds_write_b128 v10, v[212:215] offset:3072
    v_mfma_f32_16x16x32_bf16 v[236:239], v[68:71], v[84:87], v[236:239]
    ds_write_b128 v10, v[216:219] offset:4096
    v_mfma_f32_16x16x32_bf16 v[160:163], v[52:55], v[72:75], v[160:163]
    ds_write_b128 v11, v[220:223] offset:0
    v_mfma_f32_16x16x32_bf16 v[164:167], v[56:59], v[72:75], v[164:167]
    ds_write_b128 v11, v[224:227] offset:1024
    v_mfma_f32_16x16x32_bf16 v[168:171], v[60:63], v[72:75], v[168:171]
    ds_write_b128 v11, v[228:231] offset:2048
    v_mfma_f32_16x16x32_bf16 v[172:175], v[64:67], v[72:75], v[172:175]
    ds_write_b128 v11, v[232:235] offset:3072
    v_mfma_f32_16x16x32_bf16 v[176:179], v[68:71], v[72:75], v[176:179]
    ds_write_b128 v11, v[236:239] offset:4096
    v_pk_fma_f32 v[124:125], v[160:161], v[144:145], v[124:125] op_sel_hi:[1,0,1]
    v_pk_fma_f32 v[126:127], v[162:163], v[144:145], v[126:127] op_sel_hi:[1,0,1]
    v_pk_fma_f32 v[128:129], v[164:165], v[144:145], v[128:129] op_sel_hi:[1,0,1]
    v_pk_fma_f32 v[130:131], v[166:167], v[144:145], v[130:131] op_sel_hi:[1,0,1]
    v_pk_fma_f32 v[132:133], v[168:169], v[144:145], v[132:133] op_sel_hi:[1,0,1]
    v_pk_fma_f32 v[134:135], v[170:171], v[144:145], v[134:135] op_sel_hi:[1,0,1]
    v_pk_fma_f32 v[136:137], v[172:173], v[144:145], v[136:137] op_sel_hi:[1,0,1]
    v_pk_fma_f32 v[138:139], v[174:175], v[144:145], v[138:139] op_sel_hi:[1,0,1]
    v_pk_fma_f32 v[140:141], v[176:177], v[144:145], v[140:141] op_sel_hi:[1,0,1]
    v_pk_fma_f32 v[142:143], v[178:179], v[144:145], v[142:143] op_sel_hi:[1,0,1]
    s_waitcnt vmcnt(4) lgkmcnt(0)
    s_barrier
    ds_read_b128 v[52:55], v13 offset:0
    ds_read_b128 v[56:59], v13 offset:1024
    ds_read_b128 v[60:63], v13 offset:2048
    ds_read_b128 v[64:67], v13 offset:3072
    ds_read_b128 v[68:71], v13 offset:4096
    ds_read_b128 v[180:183], v8 offset:0
    ds_read_b128 v[184:187], v8 offset:1024
    ds_read_b128 v[188:191], v8 offset:2048
    ds_read_b128 v[192:195], v8 offset:3072
    ds_read_b128 v[196:199], v8 offset:4096
    ds_read_b128 v[72:75], v13 offset:5120
    ds_read_b128 v[76:79], v13 offset:6144
    ds_read_b128 v[80:83], v13 offset:7168
    ds_read_b128 v[84:87], v13 offset:8192
    ds_read_b128 v[88:91], v13 offset:9216
    s_nop 0
    s_waitcnt vmcnt(3) lgkmcnt(10)
    v_mfma_f32_16x16x32_bf16 v[160:163], v[52:55], v[36:39], 0
    ds_read_b128 v[200:203], v8 offset:5120
    v_mfma_f32_16x16x32_bf16 v[164:167], v[56:59], v[36:39], 0
    ds_read_b128 v[204:207], v8 offset:6144
    v_mfma_f32_16x16x32_bf16 v[168:171], v[60:63], v[36:39], 0
    ds_read_b128 v[208:211], v8 offset:7168
    v_mfma_f32_16x16x32_bf16 v[172:175], v[64:67], v[36:39], 0
    ds_read_b128 v[212:215], v8 offset:8192
    v_mfma_f32_16x16x32_bf16 v[176:179], v[68:71], v[36:39], 0
    ds_read_b128 v[216:219], v8 offset:9216
    s_nop 0
    s_waitcnt lgkmcnt(10)
    v_pk_fma_f32 v[124:125], v[180:181], v[146:147], v[124:125] op_sel_hi:[1,0,1]
    v_pk_fma_f32 v[126:127], v[182:183], v[146:147], v[126:127] op_sel_hi:[1,0,1]
    ds_read_b128 v[92:95], v13 offset:10240
    v_pk_fma_f32 v[128:129], v[184:185], v[146:147], v[128:129] op_sel_hi:[1,0,1]
    v_pk_fma_f32 v[130:131], v[186:187], v[146:147], v[130:131] op_sel_hi:[1,0,1]
    ds_read_b128 v[96:99], v13 offset:11264
    v_pk_fma_f32 v[132:133], v[188:189], v[146:147], v[132:133] op_sel_hi:[1,0,1]
    v_pk_fma_f32 v[134:135], v[190:191], v[146:147], v[134:135] op_sel_hi:[1,0,1]
    ds_read_b128 v[100:103], v13 offset:12288
    v_pk_fma_f32 v[136:137], v[192:193], v[146:147], v[136:137] op_sel_hi:[1,0,1]
    v_pk_fma_f32 v[138:139], v[194:195], v[146:147], v[138:139] op_sel_hi:[1,0,1]
    ds_read_b128 v[104:107], v13 offset:13312
    v_pk_fma_f32 v[140:141], v[196:197], v[146:147], v[140:141] op_sel_hi:[1,0,1]
    v_pk_fma_f32 v[142:143], v[198:199], v[146:147], v[142:143] op_sel_hi:[1,0,1]
    ds_read_b128 v[108:111], v13 offset:14336
    s_nop 0
    s_waitcnt vmcnt(2) lgkmcnt(10)
    v_mfma_f32_16x16x32_bf16 v[160:163], v[72:75], v[40:43], v[160:163]
    ds_read_b128 v[220:223], v8 offset:10240
    v_mfma_f32_16x16x32_bf16 v[164:167], v[76:79], v[40:43], v[164:167]
    ds_read_b128 v[224:227], v8 offset:11264
    v_mfma_f32_16x16x32_bf16 v[168:171], v[80:83], v[40:43], v[168:171]
    ds_read_b128 v[228:231], v8 offset:12288
    v_mfma_f32_16x16x32_bf16 v[172:175], v[84:87], v[40:43], v[172:175]
    ds_read_b128 v[232:235], v8 offset:13312
    v_mfma_f32_16x16x32_bf16 v[176:179], v[88:91], v[40:43], v[176:179]
    ds_read_b128 v[236:239], v8 offset:14336
    s_nop 0
    s_waitcnt lgkmcnt(10)
    v_pk_fma_f32 v[124:125], v[200:201], v[148:149], v[124:125] op_sel_hi:[1,0,1]
    v_pk_fma_f32 v[126:127], v[202:203], v[148:149], v[126:127] op_sel_hi:[1,0,1]
    ds_read_b128 v[112:115], v13 offset:15360
    v_pk_fma_f32 v[128:129], v[204:205], v[148:149], v[128:129] op_sel_hi:[1,0,1]
    v_pk_fma_f32 v[130:131], v[206:207], v[148:149], v[130:131] op_sel_hi:[1,0,1]
    ds_read_b128 v[116:119], v13 offset:16384
    v_pk_fma_f32 v[132:133], v[208:209], v[148:149], v[132:133] op_sel_hi:[1,0,1]
    v_pk_fma_f32 v[134:135], v[210:211], v[148:149], v[134:135] op_sel_hi:[1,0,1]
    ds_read_b128 v[120:123], v13 offset:17408
    v_pk_fma_f32 v[136:137], v[212:213], v[148:149], v[136:137] op_sel_hi:[1,0,1]
    v_pk_fma_f32 v[138:139], v[214:215], v[148:149], v[138:139] op_sel_hi:[1,0,1]
    ds_read_b128 v[16:19], v13 offset:18432
    v_pk_fma_f32 v[140:141], v[216:217], v[148:149], v[140:141] op_sel_hi:[1,0,1]
    v_pk_fma_f32 v[142:143], v[218:219], v[148:149], v[142:143] op_sel_hi:[1,0,1]
    ds_read_b128 v[20:23], v13 offset:19456
    s_nop 0
    s_waitcnt vmcnt(1) lgkmcnt(10)
    v_mfma_f32_16x16x32_bf16 v[160:163], v[92:95], v[44:47], v[160:163]
    v_mfma_f32_16x16x32_bf16 v[164:167], v[96:99], v[44:47], v[164:167]
    v_mfma_f32_16x16x32_bf16 v[168:171], v[100:103], v[44:47], v[168:171]
    v_mfma_f32_16x16x32_bf16 v[172:175], v[104:107], v[44:47], v[172:175]
    v_mfma_f32_16x16x32_bf16 v[176:179], v[108:111], v[44:47], v[176:179]
    s_nop 0
    s_waitcnt lgkmcnt(5)
    v_pk_fma_f32 v[124:125], v[220:221], v[150:151], v[124:125] op_sel_hi:[1,0,1]
    v_pk_fma_f32 v[126:127], v[222:223], v[150:151], v[126:127] op_sel_hi:[1,0,1]
    v_pk_fma_f32 v[128:129], v[224:225], v[150:151], v[128:129] op_sel_hi:[1,0,1]
    v_pk_fma_f32 v[130:131], v[226:227], v[150:151], v[130:131] op_sel_hi:[1,0,1]
    v_pk_fma_f32 v[132:133], v[228:229], v[150:151], v[132:133] op_sel_hi:[1,0,1]
    v_pk_fma_f32 v[134:135], v[230:231], v[150:151], v[134:135] op_sel_hi:[1,0,1]
    v_pk_fma_f32 v[136:137], v[232:233], v[150:151], v[136:137] op_sel_hi:[1,0,1]
    v_pk_fma_f32 v[138:139], v[234:235], v[150:151], v[138:139] op_sel_hi:[1,0,1]
    v_pk_fma_f32 v[140:141], v[236:237], v[150:151], v[140:141] op_sel_hi:[1,0,1]
    v_pk_fma_f32 v[142:143], v[238:239], v[150:151], v[142:143] op_sel_hi:[1,0,1]
    s_nop 0
    s_waitcnt vmcnt(0) lgkmcnt(0)
    v_mfma_f32_16x16x32_bf16 v[160:163], v[112:115], v[48:51], v[160:163]
    v_mfma_f32_16x16x32_bf16 v[164:167], v[116:119], v[48:51], v[164:167]
    v_mfma_f32_16x16x32_bf16 v[168:171], v[120:123], v[48:51], v[168:171]
    v_mfma_f32_16x16x32_bf16 v[172:175], v[16:19], v[48:51], v[172:175]
    v_mfma_f32_16x16x32_bf16 v[176:179], v[20:23], v[48:51], v[176:179]
    s_nop 0
    s_nop 3
    v_pk_fma_f32 v[124:125], v[160:161], v[14:15], v[124:125] op_sel:[0,1,0] op_sel_hi:[1,1,1]
    v_pk_fma_f32 v[126:127], v[162:163], v[14:15], v[126:127] op_sel:[0,1,0] op_sel_hi:[1,1,1]
    v_cvt_pk_bf16_f32 v24, v124, v125
    v_cvt_pk_bf16_f32 v25, v126, v127
    v_pk_fma_f32 v[128:129], v[164:165], v[14:15], v[128:129] op_sel:[0,1,0] op_sel_hi:[1,1,1]
    v_pk_fma_f32 v[130:131], v[166:167], v[14:15], v[130:131] op_sel:[0,1,0] op_sel_hi:[1,1,1]
    v_cvt_pk_bf16_f32 v26, v128, v129
    v_cvt_pk_bf16_f32 v27, v130, v131
    buffer_store_dwordx4 v[24:27], v12, s[12:15], s25 offen
    v_pk_fma_f32 v[132:133], v[168:169], v[14:15], v[132:133] op_sel:[0,1,0] op_sel_hi:[1,1,1]
    v_pk_fma_f32 v[134:135], v[170:171], v[14:15], v[134:135] op_sel:[0,1,0] op_sel_hi:[1,1,1]
    v_cvt_pk_bf16_f32 v28, v132, v133
    v_cvt_pk_bf16_f32 v29, v134, v135
    v_pk_fma_f32 v[136:137], v[172:173], v[14:15], v[136:137] op_sel:[0,1,0] op_sel_hi:[1,1,1]
    v_pk_fma_f32 v[138:139], v[174:175], v[14:15], v[138:139] op_sel:[0,1,0] op_sel_hi:[1,1,1]
    v_cvt_pk_bf16_f32 v30, v136, v137
    v_cvt_pk_bf16_f32 v31, v138, v139
    buffer_store_dwordx4 v[28:31], v12, s[12:15], s25 offen offset:64
    v_pk_fma_f32 v[140:141], v[176:177], v[14:15], v[140:141] op_sel:[0,1,0] op_sel_hi:[1,1,1]
    v_pk_fma_f32 v[142:143], v[178:179], v[14:15], v[142:143] op_sel:[0,1,0] op_sel_hi:[1,1,1]
    v_cvt_pk_bf16_f32 v32, v140, v141
    v_cvt_pk_bf16_f32 v33, v142, v143
    buffer_store_dwordx2 v[32:33], v0, s[12:15], s25 offen offset:128
L2_end:
    s_endpgm
L2_dump:
    s_nop 7
    ds_write_b128 v1, v[160:163] offset:5120
    ds_write_b128 v1, v[180:183] offset:10240
    ds_write_b128 v1, v[200:203] offset:15360
    v_mov_b64 v[160:161], 0
    v_mov_b64 v[162:163], 0
    ds_write_b128 v1, v[220:223] offset:0
    v_mov_b64 v[180:181], 0
    v_mov_b64 v[182:183], 0
    ds_write_b128 v1, v[164:167] offset:6144
    v_mov_b64 v[200:201], 0
    v_mov_b64 v[202:203], 0
    ds_write_b128 v1, v[184:187] offset:11264
    v_mov_b64 v[220:221], 0
    v_mov_b64 v[222:223], 0
    ds_write_b128 v1, v[204:207] offset:16384
    v_mov_b64 v[164:165], 0
    v_mov_b64 v[166:167], 0
    ds_write_b128 v1, v[224:227] offset:1024
    v_mov_b64 v[184:185], 0
    v_mov_b64 v[186:187], 0
    ds_write_b128 v1, v[168:171] offset:7168
    v_mov_b64 v[204:205], 0
    v_mov_b64 v[206:207], 0
    ds_write_b128 v1, v[188:191] offset:12288
    v_mov_b64 v[224:225], 0
    v_mov_b64 v[226:227], 0
    ds_write_b128 v1, v[208:211] offset:17408
    v_mov_b64 v[168:169], 0
    v_mov_b64 v[170:171], 0
    ds_write_b128 v1, v[228:231] offset:2048
    v_mov_b64 v[188:189], 0
    v_mov_b64 v[190:191], 0
    ds_write_b128 v1, v[172:175] offset:8192
    v_mov_b64 v[208:209], 0
    v_mov_b64 v[210:211], 0
    ds_write_b128 v1, v[192:195] offset:13312
    v_mov_b64 v[228:229], 0
    v_mov_b64 v[230:231], 0
    ds_write_b128 v1, v[212:215] offset:18432
    v_mov_b64 v[172:173], 0
    v_mov_b64 v[174:175], 0
    ds_write_b128 v1, v[232:235] offset:3072
    v_mov_b64 v[192:193], 0
    v_mov_b64 v[194:195], 0
    ds_write_b128 v1, v[176:179] offset:9216
    v_mov_b64 v[212:213], 0
    v_mov_b64 v[214:215], 0
    ds_write_b128 v1, v[196:199] offset:14336
    v_mov_b64 v[232:233], 0
    v_mov_b64 v[234:235], 0
    ds_write_b128 v1, v[216:219] offset:19456
    v_mov_b64 v[176:177], 0
    v_mov_b64 v[178:179], 0
    ds_write_b128 v1, v[236:239] offset:4096
    v_mov_b64 v[196:197], 0
    v_mov_b64 v[198:199], 0
    v_mov_b64 v[216:217], 0
    v_mov_b64 v[218:219], 0
    v_mov_b64 v[236:237], 0
    v_mov_b64 v[238:239], 0
    s_branch L2_back
L2_last:
    s_endpgm
.section .rodata,"a"
.p2align 6
.amdhsa_kernel gated_mix__sliding_local_dilated__dense_activation_relu__prompt_kernel
  .amdhsa_next_free_vgpr 256
  .amdhsa_next_free_sgpr 102
  .amdhsa_accum_offset 256
  .amdhsa_group_segment_fixed_size 0
  .amdhsa_kernarg_size 80
  .amdhsa_user_sgpr_count 2
  .amdhsa_user_sgpr_kernarg_segment_ptr 1
  .amdhsa_system_sgpr_workgroup_id_x 1
.end_amdhsa_kernel
.p2align 6
.amdhsa_kernel gm_stage2_kernel
  .amdhsa_next_free_vgpr 240
  .amdhsa_next_free_sgpr 102
  .amdhsa_accum_offset 240
  .amdhsa_group_segment_fixed_size 0
  .amdhsa_kernarg_size 80
  .amdhsa_user_sgpr_count 2
  .amdhsa_user_sgpr_kernarg_segment_ptr 1
  .amdhsa_system_sgpr_workgroup_id_x 1
.end_amdhsa_kernel
```
